```python
import torch

def _softmax(x, axis=-1):
    return torch.softmax(x, dim=axis)
def _gelu(x):
    return torch.nn.functional.gelu(x, approximate="tanh")
def _silu(x):
    return torch.nn.functional.silu(x)
def _sigmoid(x):
    return torch.sigmoid(x)
def _layernorm(x, axis=-1, eps=1e-5):
    m = x.mean(dim=axis, keepdim=True)
    v = x.var(dim=axis, keepdim=True, unbiased=False)
    return (x - m) / torch.sqrt(v + eps)
def _scatter_add(tgt, idx, src, axis=0):
    return tgt.clone().index_add_(axis, idx, src)
def _segment_sum(src, seg, n):
    out = torch.zeros((n,) + src.shape[1:], dtype=src.dtype)
    return out.index_add_(0, seg, src)
def _pad(x, pw):
    flat = tuple(v for pair in reversed(pw) for v in pair)
    return torch.nn.functional.pad(x, flat)

kernel_name = 'recurrent_scan__gqa_block_cached__geglu_ffn__decode'

def setup_inputs():

    _w = (lambda a: (lambda t: t.to(torch.bfloat16) if t.is_floating_point() else t)(torch.as_tensor(a)))
    def _A_setup():
        B, Sq, D = 2, 1, 640
        Hq, Hkv, Sk, Dh = 32, 32, 4096, 192
        assert Hq % Hkv == 0, (Hq, Hkv)
        return {
            "x": _w((lambda *s: torch.randn(*s, dtype=torch.bfloat16) * 0.05)(B, Sq, D)),
            "k_cache": _w((lambda *s: torch.randn(*s, dtype=torch.bfloat16) * 1.6)(B, Hkv, Sk, Dh)),
            "v_cache": _w((lambda *s: torch.randn(*s, dtype=torch.bfloat16) * 0.2)(B, Hkv, Sk, Dh)),
            "wq": _w((lambda *s: torch.randn(*s, dtype=torch.bfloat16) * 1.6)(D, Hq * Dh) * (D ** -0.5)),
            "wo": _w((lambda *s: torch.randn(*s, dtype=torch.bfloat16) * 0.2)(Hq * Dh, D) * ((Hq * Dh) ** -0.5)),
        }
    _A_in = _A_setup()

    def _B_setup():
        B, S, D, F = 2, 1, 640, 1536
        return {
            "x": _w((lambda *s: torch.randn(*s, dtype=torch.bfloat16) * 0.05)(B, S, D)),
            "w_gate": _w((lambda *s: torch.randn(*s, dtype=torch.bfloat16) * 0.1)(D, F)),
            "w_up": _w((lambda *s: torch.randn(*s, dtype=torch.bfloat16) * 0.1)(D, F)),
            "w_down": _w((lambda *s: torch.randn(*s, dtype=torch.bfloat16) * 0.1)(F, D)),
        }
    _B_in = _B_setup()

    return {
        "A_x": _A_in["x"],
        "A_k_cache": _A_in["k_cache"],
        "A_v_cache": _A_in["v_cache"],
        "A_wq": _A_in["wq"],
        "A_wo": _A_in["wo"],
        "B_x": _B_in["x"],
        "B_w_gate": _B_in["w_gate"],
        "B_w_up": _B_in["w_up"],
        "B_w_down": _B_in["w_down"],
    }

def reference(A_x, A_k_cache, A_v_cache, A_wq, A_wo, B_x, B_w_gate, B_w_up, B_w_down):
    def _A_ref(x, k_cache, v_cache, wq, wo):
        B, Sq, D = x.shape
        Hq, Dh = 32, 192
        Hkv = k_cache.shape[1]
        rep = Hq // Hkv
        q = (lambda x, *d: x.permute(*d))((x @ wq).reshape(B, Sq, Hq, Dh), 0, 2, 1, 3)
        k = (lambda x, n, axis: torch.repeat_interleave(x, n, dim=axis))(k_cache, rep, axis=1)
        v = (lambda x, n, axis: torch.repeat_interleave(x, n, dim=axis))(v_cache, rep, axis=1)
        scores = torch.einsum("bhqd,bhkd->bhqk", q, k) * (Dh ** -0.5)
        p = _softmax(scores, axis=-1)
        o = torch.einsum("bhqk,bhkd->bhqd", p, v)
        return (lambda x, *d: x.permute(*d))(o, 0, 2, 1, 3).reshape(B, Sq, Hq * Dh) @ wo

    def _B_ref(x, w_gate, w_up, w_down):
        return (_gelu(x @ w_gate) * (x @ w_up)) @ w_down

    x = A_x
    xn = _layernorm(x, axis=-1)
    s = _A_ref(xn, A_k_cache, A_v_cache, A_wq, A_wo)
    g = _silu(_B_ref(xn, B_w_gate, B_w_up, B_w_down))
    return x + s * g
```

```asm
; @launch grid=(256,1,1) block=(256,1,1) lds=57344
.amdgcn_target "amdgcn-amd-amdhsa--gfx950"
.text
.globl recurrent_scan__gqa_block_cached__geglu_ffn__decode_kernel
.p2align 8
.type recurrent_scan__gqa_block_cached__geglu_ffn__decode_kernel,@function
recurrent_scan__gqa_block_cached__geglu_ffn__decode_kernel:
  s_cmp_ge_u32 s2, 256
  s_cbranch_scc1 L_end
  s_load_dwordx16 s[4:19], s[0:1], 0
  s_load_dwordx8 s[20:27], s[0:1], 64
  v_and_b32 v1, 63, v0
  v_lshrrev_b32 v82, 6, v0
  v_lshrrev_b32 v83, 3, v1
  v_and_b32 v84, 7, v1
  v_readfirstlane_b32 s72, v82
  v_mul_u32_u24 v2, 384, v83
  v_lshl_add_u32 v2, v84, 4, v2
  v_mul_u32_u24 v85, 3072, v82
  v_add_u32 v2, v2, v85
  v_lshl_add_u32 v3, v82, 3, v83
  v_mul_u32_u24 v3, 12288, v3
  v_lshl_add_u32 v3, v84, 4, v3
  v_lshrrev_b32 v85, 5, v1
  v_mul_u32_u24 v85, 1280, v85
  v_and_b32 v87, 31, v1
  v_lshl_add_u32 v86, v87, 4, v85
  v_lshl_add_u32 v87, v87, 3, v85
  v_lshrrev_b32 v85, 4, v1
  v_lshl_add_u32 v81, v82, 2, v85
  v_mul_u32_u24 v81, 3072, v81
  v_and_b32 v83, 15, v1
  v_lshl_add_u32 v81, v83, 4, v81
  s_and_b32 s81, s2, 7
  s_lshr_b32 s82, s2, 3
  s_lshr_b32 s83, s82, 3
  s_lshl_b32 s74, s81, 2
  s_add_u32 s74, s74, s83
  s_and_b32 s69, s82, 7
  s_lshr_b32 s73, s69, 2
  s_and_b32 s82, s82, 3
  s_lshl_b32 s75, s74, 2
  s_add_u32 s75, s75, s82
  s_lshl_b32 s81, s73, 7
  s_add_u32 s81, s81, s75
  s_and_b32 s81, s81, 252
  s_mul_i32 s82, s82, 12288
  v_add_u32 v2, s82, v2
  s_mul_i32 s81, s81, 393216
  s_mov_b32 s30, 1572864
  s_mov_b32 s31, 0x20000
  s_mov_b32 s46, 2560
  s_mov_b32 s47, 0x20000
  s_mov_b32 s55, s69
  s_mov_b32 s3, s74
  s_cmp_ge_u32 s55, 3
  s_cselect_b32 s54, 1, 0
  s_mul_i32 s82, s54, 3
  s_sub_u32 s55, s55, s82
  s_mul_i32 s89, s54, 3932160
  s_mul_i32 s80, s54, 0
  s_sub_u32 s80, 3920000, s80
  s_mul_i32 s82, s3, 384
  s_add_u32 s89, s89, s82
  s_lshl_b32 s82, s55, 7
  s_add_u32 s89, s89, s82
  s_lshl_b32 s82, s74, 1
  s_add_u32 s82, s82, s69
  s_sub_u32 s82, s82, 6
  s_and_b32 s82, s82, 63
  s_mul_i32 s77, s82, 43
  s_lshr_b32 s77, s77, 9
  s_mul_i32 s83, s77, 12
  s_sub_u32 s76, s82, s83
  s_cmp_lt_u32 s82, 60
  s_cselect_b32 s71, 390400, 0
  s_min_u32 s77, s77, 4
  s_mul_i32 s88, s77, 393216
  s_lshl_b32 s83, s76, 8
  s_add_u32 s88, s88, s83
  s_mov_b32 s39, 0x20000
  s_mov_b32 s51, 0x20000
  s_mov_b32 s53, 786432
  s_cmp_ge_u32 s69, 6
  s_cselect_b32 s38, s71, s80
  s_cselect_b32 s50, s71, s80
  s_cselect_b32 s52, 0, 393216
  s_cselect_b32 s53, 49152, s53
  s_cselect_b32 s89, s88, s89
  s_cselect_b64 vcc, -1, 0
  s_waitcnt lgkmcnt(0)
  s_cselect_b32 s36, s16, s10
  s_cselect_b32 s37, s17, s11
  s_cselect_b32 s48, s18, s10
  s_cselect_b32 s49, s19, s11
  s_mov_b32 s44, s4
  s_mov_b32 s45, s5
  v_cndmask_b32 v3, v3, v81, vcc
  buffer_load_dwordx4 v[18:21], v86, s[44:47], 0 offen
  buffer_load_dwordx4 v[22:25], v86, s[44:47], 0 offen offset:512
  buffer_load_dwordx2 v[26:27], v87, s[44:47], 0 offen offset:1024
  s_add_u32 s36, s36, s89
  s_addc_u32 s37, s37, 0
  s_add_u32 s48, s48, s89
  s_addc_u32 s49, s49, 0
  s_add_u32 s28, s6, s81
  s_addc_u32 s29, s7, 0
  s_add_u32 s32, s8, s81
  s_addc_u32 s33, s9, 0
  s_mov_b32 s88, 0
  buffer_load_dwordx4 a[0:3], v3, s[36:39], s88 offen
  s_add_u32 s80, s88, s52
  buffer_load_dwordx4 a[4:7], v3, s[48:51], s80 offen
  s_add_u32 s88, s88, s53
  buffer_load_dwordx4 a[8:11], v3, s[36:39], s88 offen
  s_add_u32 s80, s88, s52
  buffer_load_dwordx4 a[12:15], v3, s[48:51], s80 offen
  s_add_u32 s88, s88, s53
  buffer_load_dwordx4 a[16:19], v3, s[36:39], s88 offen
  s_add_u32 s80, s88, s52
  buffer_load_dwordx4 a[20:23], v3, s[48:51], s80 offen
  s_add_u32 s88, s88, s53
  buffer_load_dwordx4 a[24:27], v3, s[36:39], s88 offen
  s_add_u32 s80, s88, s52
  buffer_load_dwordx4 a[28:31], v3, s[48:51], s80 offen
  s_add_u32 s88, s88, s53
  buffer_load_dwordx4 a[32:35], v3, s[36:39], s88 offen
  s_add_u32 s80, s88, s52
  buffer_load_dwordx4 a[36:39], v3, s[48:51], s80 offen
  s_add_u32 s88, s88, s53
  buffer_load_dwordx4 a[40:43], v3, s[36:39], s88 offen
  s_add_u32 s80, s88, s52
  buffer_load_dwordx4 a[44:47], v3, s[48:51], s80 offen
  s_add_u32 s88, s88, s53
  buffer_load_dwordx4 a[48:51], v3, s[36:39], s88 offen
  s_add_u32 s80, s88, s52
  buffer_load_dwordx4 a[52:55], v3, s[48:51], s80 offen
  s_add_u32 s88, s88, s53
  buffer_load_dwordx4 a[56:59], v3, s[36:39], s88 offen
  s_add_u32 s80, s88, s52
  buffer_load_dwordx4 a[60:63], v3, s[48:51], s80 offen
  s_add_u32 s84, s26, 1253376
  s_addc_u32 s85, s27, 0
  s_load_dword s68, s[84:85], 0
  s_bfe_u32 s81, s2, 0x20003
  s_mul_i32 s15, s81, 0
  s_mul_i32 s81, s73, 4
  s_add_u32 s15, s15, s81
  s_lshr_b32 s81, s2, 6
  s_mul_i32 s81, s81, 8
  s_add_u32 s15, s15, s81
  s_and_b32 s81, s2, 7
  s_mul_i32 s81, s81, 0
  s_add_u32 s15, s15, s81
  s_mov_b32 s34, 1572864
  s_mov_b32 s35, 0x20000
  s_mul_i32 s81, s74, 245760
  s_add_u32 s40, s12, s81
  s_addc_u32 s41, s13, 0
  s_mov_b32 s42, 245760
  s_mov_b32 s43, 0x20000
  s_mov_b32 s60, s26
  s_mov_b32 s61, s27
  s_mov_b32 s62, 1257472
  s_mov_b32 s63, 0x20000
  s_mov_b32 s64, s22
  s_mov_b32 s65, s23
  s_mov_b32 s66, 2560
  s_mov_b32 s67, 0x20000
  s_sub_u32 s83, s69, 0
  s_lshl_b32 s81, s74, 2
  s_add_u32 s81, s81, s83
  s_and_b32 s81, s81, 127
  s_mul_i32 s79, s81, 205
  s_lshr_b32 s79, s79, 10
  s_mul_i32 s82, s79, 5
  s_sub_u32 s78, s81, s82
  s_cmp_lt_u32 s83, 4
  s_cselect_b32 s81, s81, 255
  s_cmp_lt_u32 s81, 120
  s_cselect_b32 s58, 1966080, 0
  s_cselect_b32 s94, 565248, 0
  s_cselect_b32 s70, 1, 0
  s_mov_b32 s56, s20
  s_mov_b32 s57, s21
  s_mov_b32 s59, 0x20000
  s_mov_b32 s92, s26
  s_mov_b32 s93, s27
  s_mov_b32 s95, 0x20000
  s_mov_b32 s86, 0x00ff00ff
  s_mov_b32 s87, 0xff00ff00
  v_mul_u32_u24 v4, 1280, v85
  v_lshl_add_u32 v4, v83, 4, v4
  s_mul_i32 s81, s72, 61440
  v_add_u32 v4, s81, v4
  v_lshrrev_b32 v82, 5, v1
  v_and_b32 v85, 16, v1
  v_lshl_add_u32 v80, v84, 5, v85
  v_mul_u32_u24 v78, 784, v82
  v_add_u32 v78, v78, v80
  s_mul_i32 s81, s72, 1568
  v_add_u32 v78, s81, v78
  v_mul_u32_u24 v81, 528, v82
  v_add_u32 v81, v81, v80
  s_mul_i32 s81, s72, 1056
  v_add_u32 v81, s81, v81
  v_lshlrev_b32 v79, 9, v82
  v_lshl_add_u32 v79, v83, 5, v79
  v_add_u32 v79, v79, v85
  v_lshrrev_b32 v82, 3, v0
  v_lshlrev_b32 v82, 14, v82
  v_lshl_add_u32 v82, v84, 4, v82
  s_mul_i32 s81, s73, 327680
  s_lshl_b32 s82, s75, 7
  s_add_u32 s81, s81, s82
  s_add_u32 s81, s81, 565248
  v_cmp_gt_u32 vcc, 160, v0
  v_add_u32 v82, s81, v82
  v_mov_b32 v5, 2147483632
  v_cndmask_b32 v5, v5, v82, vcc
  s_mov_b32 s16, 0x03020104
  s_mov_b32 s17, 0x03020105
  s_mov_b32 s18, 0x03020106
  s_mov_b32 s19, 0x03020107
  s_mov_b32 s14, 0x0c0c0400
  v_and_b32 v82, 1, v1
  v_lshlrev_b32 v82, 4, v82
  v_mov_b32 v83, 0xffff
  v_lshlrev_b32 v82, v82, v83
  v_bfe_u32 v83, v1, 1, 2
  v_cmp_eq_u32 vcc, 0, v83
  s_nop 1
  v_cndmask_b32 v6, 0, v82, vcc
  v_cmp_eq_u32 vcc, 1, v83
  s_nop 1
  v_cndmask_b32 v7, 0, v82, vcc
  v_cmp_eq_u32 vcc, 2, v83
  s_nop 1
  v_cndmask_b32 v8, 0, v82, vcc
  v_cmp_eq_u32 vcc, 3, v83
  s_nop 1
  v_cndmask_b32 v9, 0, v82, vcc
  s_lshl_b32 s81, s79, 2
  s_add_u32 s81, s81, s72
  s_mul_i32 s82, s81, 20480
  s_lshl_b32 s83, s78, 8
  s_add_u32 s82, s82, s83
  s_mul_i32 s83, s72, 61440
  v_subrev_u32 v83, s83, v4
  buffer_load_dwordx4 a[240:243], v83, s[56:59], s82 offen
  s_add_u32 s82, s82, 5120
  buffer_load_dwordx4 a[244:247], v83, s[56:59], s82 offen
  s_add_u32 s82, s82, 5120
  buffer_load_dwordx4 a[248:251], v83, s[56:59], s82 offen
  s_add_u32 s82, s82, 5120
  buffer_load_dwordx4 a[252:255], v83, s[56:59], s82 offen
  s_waitcnt vmcnt(20)
  v_lshlrev_b32 v28, 16, v18
  v_and_b32 v29, 0xffff0000, v18
  v_lshlrev_b32 v30, 16, v19
  v_and_b32 v31, 0xffff0000, v19
  v_lshlrev_b32 v32, 16, v20
  v_and_b32 v33, 0xffff0000, v20
  v_lshlrev_b32 v34, 16, v21
  v_and_b32 v35, 0xffff0000, v21
  v_lshlrev_b32 v36, 16, v22
  v_and_b32 v37, 0xffff0000, v22
  v_lshlrev_b32 v38, 16, v23
  v_and_b32 v39, 0xffff0000, v23
  v_lshlrev_b32 v40, 16, v24
  v_and_b32 v41, 0xffff0000, v24
  v_lshlrev_b32 v42, 16, v25
  v_and_b32 v43, 0xffff0000, v25
  v_lshlrev_b32 v44, 16, v26
  v_and_b32 v45, 0xffff0000, v26
  v_lshlrev_b32 v46, 16, v27
  v_and_b32 v47, 0xffff0000, v27
  v_add_f32 v48, v28, v32
  v_add_f32 v49, v29, v33
  v_add_f32 v50, v30, v34
  v_add_f32 v51, v31, v35
  v_add_f32 v48, v48, v36
  v_add_f32 v49, v49, v37
  v_add_f32 v50, v50, v38
  v_add_f32 v51, v51, v39
  v_add_f32 v48, v48, v40
  v_add_f32 v49, v49, v41
  v_add_f32 v50, v50, v42
  v_add_f32 v51, v51, v43
  v_add_f32 v48, v48, v44
  v_add_f32 v49, v49, v45
  v_add_f32 v50, v50, v46
  v_add_f32 v51, v51, v47
  v_add_f32 v48, v48, v49
  v_add_f32 v50, v50, v51
  v_add_f32 v48, v48, v50
  s_nop 1
  v_add_f32_dpp v48, v48, v48 quad_perm:[1,0,3,2] row_mask:0xf bank_mask:0xf
  s_nop 1
  v_add_f32_dpp v48, v48, v48 quad_perm:[2,3,0,1] row_mask:0xf bank_mask:0xf
  s_nop 1
  v_add_f32_dpp v48, v48, v48 row_half_mirror row_mask:0xf bank_mask:0xf
  s_nop 1
  v_add_f32_dpp v48, v48, v48 row_mirror row_mask:0xf bank_mask:0xf
  v_mov_b32 v49, v48
  s_nop 1
  v_permlane16_swap_b32 v48, v49
  s_nop 1
  v_add_f32 v48, v48, v49
  s_add_u32 s80, s15, 0
  s_and_b32 s80, s80, 31
  s_mul_i32 s80, s80, 49152
  buffer_load_dwordx4 v[88:91], v2, s[28:31], s80 offen offset:0 nt
  buffer_load_dwordx4 v[92:95], v2, s[28:31], s80 offen offset:128 nt
  buffer_load_dwordx4 v[96:99], v2, s[28:31], s80 offen offset:256 nt
  v_mul_f32 v48, 0x3acccccd, v48
  v_sub_f32 v18, v28, v48
  v_mul_f32 v52, v18, v18
  v_sub_f32 v19, v29, v48
  v_mul_f32 v53, v19, v19
  v_sub_f32 v20, v30, v48
  v_mul_f32 v54, v20, v20
  v_sub_f32 v21, v31, v48
  v_mul_f32 v55, v21, v21
  v_sub_f32 v18, v32, v48
  v_fmac_f32 v52, v18, v18
  v_sub_f32 v19, v33, v48
  v_fmac_f32 v53, v19, v19
  v_sub_f32 v20, v34, v48
  v_fmac_f32 v54, v20, v20
  v_sub_f32 v21, v35, v48
  v_fmac_f32 v55, v21, v21
  v_sub_f32 v18, v36, v48
  v_fmac_f32 v52, v18, v18
  v_sub_f32 v19, v37, v48
  v_fmac_f32 v53, v19, v19
  v_sub_f32 v20, v38, v48
  v_fmac_f32 v54, v20, v20
  v_sub_f32 v21, v39, v48
  v_fmac_f32 v55, v21, v21
  v_sub_f32 v18, v40, v48
  v_fmac_f32 v52, v18, v18
  v_sub_f32 v19, v41, v48
  v_fmac_f32 v53, v19, v19
  v_sub_f32 v20, v42, v48
  v_fmac_f32 v54, v20, v20
  v_sub_f32 v21, v43, v48
  v_fmac_f32 v55, v21, v21
  v_sub_f32 v18, v44, v48
  v_fmac_f32 v52, v18, v18
  v_sub_f32 v19, v45, v48
  v_fmac_f32 v53, v19, v19
  v_sub_f32 v20, v46, v48
  v_fmac_f32 v54, v20, v20
  v_sub_f32 v21, v47, v48
  v_fmac_f32 v55, v21, v21
  v_add_f32 v52, v52, v53
  v_add_f32 v54, v54, v55
  v_add_f32 v52, v52, v54
  s_nop 1
  v_add_f32_dpp v52, v52, v52 quad_perm:[1,0,3,2] row_mask:0xf bank_mask:0xf
  s_nop 1
  v_add_f32_dpp v52, v52, v52 quad_perm:[2,3,0,1] row_mask:0xf bank_mask:0xf
  s_nop 1
  v_add_f32_dpp v52, v52, v52 row_half_mirror row_mask:0xf bank_mask:0xf
  s_nop 1
  v_add_f32_dpp v52, v52, v52 row_mirror row_mask:0xf bank_mask:0xf
  v_mov_b32 v53, v52
  s_nop 1
  v_permlane16_swap_b32 v52, v53
  s_nop 1
  v_add_f32 v52, v52, v53
  s_add_u32 s80, s15, 1
  s_and_b32 s80, s80, 31
  s_mul_i32 s80, s80, 49152
  buffer_load_dwordx4 v[100:103], v2, s[28:31], s80 offen offset:0 nt
  buffer_load_dwordx4 v[104:107], v2, s[28:31], s80 offen offset:128 nt
  buffer_load_dwordx4 v[108:111], v2, s[28:31], s80 offen offset:256 nt
  v_mul_f32 v52, 0x3acccccd, v52
  v_cvt_pk_bf16_f32 v48, v48, v52
  v_and_b32 v52, 0xffff0000, v48
  v_lshlrev_b32 v48, 16, v48
  v_add_f32 v52, 0x3727c5ac, v52
  v_cvt_pk_bf16_f32 v52, v52, v52
  v_and_b32 v52, 0xffff0000, v52
  v_sqrt_f32 v52, v52
  s_nop 0
  v_cvt_pk_bf16_f32 v52, v52, v52
  v_and_b32 v52, 0xffff0000, v52
  v_rcp_f32 v53, v52
  v_sub_f32 v28, v28, v48
  v_sub_f32 v29, v29, v48
  v_cvt_pk_bf16_f32 v18, v28, v29
  v_lshlrev_b32 v28, 16, v18
  v_and_b32 v29, 0xffff0000, v18
  v_mul_f32 v19, v28, v53
  v_mul_f32 v20, v29, v53
  v_fma_f32 v28, -v19, v52, v28
  v_fma_f32 v29, -v20, v52, v29
  v_fmac_f32 v19, v28, v53
  v_fmac_f32 v20, v29, v53
  v_cvt_pk_bf16_f32 v28, v19, v19
  v_cvt_pk_bf16_f32 v29, v20, v20
  v_sub_f32 v30, v30, v48
  v_sub_f32 v31, v31, v48
  v_cvt_pk_bf16_f32 v18, v30, v31
  v_lshlrev_b32 v30, 16, v18
  v_and_b32 v31, 0xffff0000, v18
  v_mul_f32 v19, v30, v53
  v_mul_f32 v20, v31, v53
  v_fma_f32 v30, -v19, v52, v30
  v_fma_f32 v31, -v20, v52, v31
  v_fmac_f32 v19, v30, v53
  v_fmac_f32 v20, v31, v53
  v_cvt_pk_bf16_f32 v30, v19, v19
  v_cvt_pk_bf16_f32 v31, v20, v20
  v_sub_f32 v32, v32, v48
  v_sub_f32 v33, v33, v48
  v_cvt_pk_bf16_f32 v18, v32, v33
  v_lshlrev_b32 v32, 16, v18
  v_and_b32 v33, 0xffff0000, v18
  v_mul_f32 v19, v32, v53
  v_mul_f32 v20, v33, v53
  v_fma_f32 v32, -v19, v52, v32
  v_fma_f32 v33, -v20, v52, v33
  v_fmac_f32 v19, v32, v53
  v_fmac_f32 v20, v33, v53
  v_cvt_pk_bf16_f32 v32, v19, v19
  v_cvt_pk_bf16_f32 v33, v20, v20
  v_sub_f32 v34, v34, v48
  v_sub_f32 v35, v35, v48
  v_cvt_pk_bf16_f32 v18, v34, v35
  v_lshlrev_b32 v34, 16, v18
  v_and_b32 v35, 0xffff0000, v18
  v_mul_f32 v19, v34, v53
  v_mul_f32 v20, v35, v53
  v_fma_f32 v34, -v19, v52, v34
  v_fma_f32 v35, -v20, v52, v35
  v_fmac_f32 v19, v34, v53
  v_fmac_f32 v20, v35, v53
  v_cvt_pk_bf16_f32 v34, v19, v19
  v_cvt_pk_bf16_f32 v35, v20, v20
  v_sub_f32 v36, v36, v48
  v_sub_f32 v37, v37, v48
  v_cvt_pk_bf16_f32 v18, v36, v37
  v_lshlrev_b32 v36, 16, v18
  v_and_b32 v37, 0xffff0000, v18
  v_mul_f32 v19, v36, v53
  v_mul_f32 v20, v37, v53
  v_fma_f32 v36, -v19, v52, v36
  v_fma_f32 v37, -v20, v52, v37
  v_fmac_f32 v19, v36, v53
  v_fmac_f32 v20, v37, v53
  v_cvt_pk_bf16_f32 v36, v19, v19
  v_cvt_pk_bf16_f32 v37, v20, v20
  s_add_u32 s80, s15, 2
  s_and_b32 s80, s80, 31
  s_mul_i32 s80, s80, 49152
  buffer_load_dwordx4 v[112:115], v2, s[28:31], s80 offen offset:0 nt
  buffer_load_dwordx4 v[116:119], v2, s[28:31], s80 offen offset:128 nt
  buffer_load_dwordx4 v[120:123], v2, s[28:31], s80 offen offset:256 nt
  v_sub_f32 v38, v38, v48
  v_sub_f32 v39, v39, v48
  v_cvt_pk_bf16_f32 v18, v38, v39
  v_lshlrev_b32 v38, 16, v18
  v_and_b32 v39, 0xffff0000, v18
  v_mul_f32 v19, v38, v53
  v_mul_f32 v20, v39, v53
  v_fma_f32 v38, -v19, v52, v38
  v_fma_f32 v39, -v20, v52, v39
  v_fmac_f32 v19, v38, v53
  v_fmac_f32 v20, v39, v53
  v_cvt_pk_bf16_f32 v38, v19, v19
  v_cvt_pk_bf16_f32 v39, v20, v20
  v_sub_f32 v40, v40, v48
  v_sub_f32 v41, v41, v48
  v_cvt_pk_bf16_f32 v18, v40, v41
  v_lshlrev_b32 v40, 16, v18
  v_and_b32 v41, 0xffff0000, v18
  v_mul_f32 v19, v40, v53
  v_mul_f32 v20, v41, v53
  v_fma_f32 v40, -v19, v52, v40
  v_fma_f32 v41, -v20, v52, v41
  v_fmac_f32 v19, v40, v53
  v_fmac_f32 v20, v41, v53
  v_cvt_pk_bf16_f32 v40, v19, v19
  v_cvt_pk_bf16_f32 v41, v20, v20
  v_sub_f32 v42, v42, v48
  v_sub_f32 v43, v43, v48
  v_cvt_pk_bf16_f32 v18, v42, v43
  v_lshlrev_b32 v42, 16, v18
  v_and_b32 v43, 0xffff0000, v18
  v_mul_f32 v19, v42, v53
  v_mul_f32 v20, v43, v53
  v_fma_f32 v42, -v19, v52, v42
  v_fma_f32 v43, -v20, v52, v43
  v_fmac_f32 v19, v42, v53
  v_fmac_f32 v20, v43, v53
  v_cvt_pk_bf16_f32 v42, v19, v19
  v_cvt_pk_bf16_f32 v43, v20, v20
  v_sub_f32 v44, v44, v48
  v_sub_f32 v45, v45, v48
  v_cvt_pk_bf16_f32 v18, v44, v45
  v_lshlrev_b32 v44, 16, v18
  v_and_b32 v45, 0xffff0000, v18
  v_mul_f32 v19, v44, v53
  v_mul_f32 v20, v45, v53
  v_fma_f32 v44, -v19, v52, v44
  v_fma_f32 v45, -v20, v52, v45
  v_fmac_f32 v19, v44, v53
  v_fmac_f32 v20, v45, v53
  v_cvt_pk_bf16_f32 v44, v19, v19
  v_cvt_pk_bf16_f32 v45, v20, v20
  v_sub_f32 v46, v46, v48
  v_sub_f32 v47, v47, v48
  v_cvt_pk_bf16_f32 v18, v46, v47
  v_lshlrev_b32 v46, 16, v18
  v_and_b32 v47, 0xffff0000, v18
  v_mul_f32 v19, v46, v53
  v_mul_f32 v20, v47, v53
  v_fma_f32 v46, -v19, v52, v46
  v_fma_f32 v47, -v20, v52, v47
  v_fmac_f32 v19, v46, v53
  v_fmac_f32 v20, v47, v53
  v_cvt_pk_bf16_f32 v46, v19, v19
  v_cvt_pk_bf16_f32 v47, v20, v20
  v_lshlrev_b32 v86, 1, v86
  v_lshlrev_b32 v87, 1, v87
  ds_write_b128 v86, v[28:31] offset:0
  ds_write_b128 v86, v[32:35] offset:16
  ds_write_b128 v86, v[36:39] offset:1024
  ds_write_b128 v86, v[40:43] offset:1040
  ds_write_b128 v87, v[44:47] offset:2048
  v_mov_b32 v86, 36928
  v_mov_b32 v87, 0
  s_waitcnt lgkmcnt(0)
  s_add_u32 s68, s68, 1
  s_and_b32 s81, s68, 0xff
  s_mul_i32 s82, s81, 0x01010101
  ds_write_b32 v86, v87
  s_xor_b32 s82, s82, 0xa5c35a00
  v_mov_b32 v76, s82
  s_add_u32 s80, s15, 3
  s_and_b32 s80, s80, 31
  s_mul_i32 s80, s80, 49152
  buffer_load_dwordx4 v[124:127], v2, s[28:31], s80 offen offset:0 nt
  buffer_load_dwordx4 v[128:131], v2, s[28:31], s80 offen offset:128 nt
  buffer_load_dwordx4 v[132:135], v2, s[28:31], s80 offen offset:256 nt
  s_add_u32 s80, s15, 4
  s_and_b32 s80, s80, 31
  s_mul_i32 s80, s80, 49152
  buffer_load_dwordx4 v[136:139], v2, s[28:31], s80 offen offset:0 nt
  buffer_load_dwordx4 v[140:143], v2, s[28:31], s80 offen offset:128 nt
  buffer_load_dwordx4 v[144:147], v2, s[28:31], s80 offen offset:256 nt
  s_cmp_eq_u32 s52, 0
  s_cbranch_scc1 L_frole
  s_mul_i32 s81, s54, 1280
  s_lshl_b32 s82, s72, 5
  s_add_u32 s81, s81, s82
  v_lshrrev_b32 v82, 3, v1
  v_lshlrev_b32 v83, 2, v82
  v_add_u32 v83, s81, v83
  ds_read_b32 v42, v83 offset:0
  ds_read_b32 v43, v83 offset:2560
  ds_read_b32 v44, v83 offset:128
  ds_read_b32 v45, v83 offset:2688
  ds_read_b32 v46, v83 offset:256
  ds_read_b32 v47, v83 offset:2816
  ds_read_b32 v48, v83 offset:384
  ds_read_b32 v49, v83 offset:2944
  ds_read_b32 v50, v83 offset:512
  ds_read_b32 v51, v83 offset:3072
  ds_read_b32 v52, v83 offset:640
  ds_read_b32 v53, v83 offset:3200
  ds_read_b32 v54, v83 offset:768
  ds_read_b32 v55, v83 offset:3328
  s_waitcnt lgkmcnt(8)
  ds_read_b32 v56, v83 offset:896
  ds_read_b32 v57, v83 offset:3456
  ds_read_b32 v58, v83 offset:1024
  ds_read_b32 v59, v83 offset:3584
  ds_read_b32 v60, v83 offset:1152
  ds_read_b32 v61, v83 offset:3712
  s_waitcnt lgkmcnt(8)
  s_waitcnt lgkmcnt(0)
  v_and_b32 v10, v42, v6
  v_and_b32 v11, v42, v7
  v_and_b32 v12, v42, v8
  v_and_b32 v13, v42, v9
  v_and_b32 v14, v43, v6
  v_and_b32 v15, v43, v7
  v_and_b32 v16, v43, v8
  v_and_b32 v17, v43, v9
  s_waitcnt vmcnt(19)
  v_mfma_f32_16x16x32_bf16 v[18:21], v[10:13], a[0:3], 0
  v_mfma_f32_16x16x32_bf16 v[22:25], v[14:17], a[0:3], 0
  v_and_b32 v10, v44, v6
  v_and_b32 v11, v44, v7
  v_and_b32 v12, v44, v8
  v_and_b32 v13, v44, v9
  v_and_b32 v14, v45, v6
  v_and_b32 v15, v45, v7
  v_and_b32 v16, v45, v8
  v_and_b32 v17, v45, v9
  s_nop 0
  v_mfma_f32_16x16x32_bf16 v[18:21], v[10:13], a[4:7], v[18:21]
  v_mfma_f32_16x16x32_bf16 v[22:25], v[14:17], a[4:7], v[22:25]
  v_and_b32 v10, v46, v6
  v_and_b32 v11, v46, v7
  v_and_b32 v12, v46, v8
  v_and_b32 v13, v46, v9
  v_and_b32 v14, v47, v6
  v_and_b32 v15, v47, v7
  v_and_b32 v16, v47, v8
  v_and_b32 v17, v47, v9
  s_nop 0
  v_mfma_f32_16x16x32_bf16 v[18:21], v[10:13], a[8:11], v[18:21]
  v_mfma_f32_16x16x32_bf16 v[22:25], v[14:17], a[8:11], v[22:25]
  v_and_b32 v10, v48, v6
  v_and_b32 v11, v48, v7
  v_and_b32 v12, v48, v8
  v_and_b32 v13, v48, v9
  v_and_b32 v14, v49, v6
  v_and_b32 v15, v49, v7
  v_and_b32 v16, v49, v8
  v_and_b32 v17, v49, v9
  s_nop 0
  v_mfma_f32_16x16x32_bf16 v[18:21], v[10:13], a[12:15], v[18:21]
  v_mfma_f32_16x16x32_bf16 v[22:25], v[14:17], a[12:15], v[22:25]
  v_and_b32 v10, v50, v6
  v_and_b32 v11, v50, v7
  v_and_b32 v12, v50, v8
  v_and_b32 v13, v50, v9
  v_and_b32 v14, v51, v6
  v_and_b32 v15, v51, v7
  v_and_b32 v16, v51, v8
  v_and_b32 v17, v51, v9
  s_nop 0
  v_mfma_f32_16x16x32_bf16 v[18:21], v[10:13], a[16:19], v[18:21]
  v_mfma_f32_16x16x32_bf16 v[22:25], v[14:17], a[16:19], v[22:25]
  v_and_b32 v10, v52, v6
  v_and_b32 v11, v52, v7
  v_and_b32 v12, v52, v8
  v_and_b32 v13, v52, v9
  v_and_b32 v14, v53, v6
  v_and_b32 v15, v53, v7
  v_and_b32 v16, v53, v8
  v_and_b32 v17, v53, v9
  s_nop 0
  v_mfma_f32_16x16x32_bf16 v[18:21], v[10:13], a[20:23], v[18:21]
  v_mfma_f32_16x16x32_bf16 v[22:25], v[14:17], a[20:23], v[22:25]
  v_and_b32 v10, v54, v6
  v_and_b32 v11, v54, v7
  v_and_b32 v12, v54, v8
  v_and_b32 v13, v54, v9
  v_and_b32 v14, v55, v6
  v_and_b32 v15, v55, v7
  v_and_b32 v16, v55, v8
  v_and_b32 v17, v55, v9
  s_nop 0
  v_mfma_f32_16x16x32_bf16 v[18:21], v[10:13], a[24:27], v[18:21]
  v_mfma_f32_16x16x32_bf16 v[22:25], v[14:17], a[24:27], v[22:25]
  v_and_b32 v10, v56, v6
  v_and_b32 v11, v56, v7
  v_and_b32 v12, v56, v8
  v_and_b32 v13, v56, v9
  v_and_b32 v14, v57, v6
  v_and_b32 v15, v57, v7
  v_and_b32 v16, v57, v8
  v_and_b32 v17, v57, v9
  s_nop 0
  v_mfma_f32_16x16x32_bf16 v[18:21], v[10:13], a[28:31], v[18:21]
  v_mfma_f32_16x16x32_bf16 v[22:25], v[14:17], a[28:31], v[22:25]
  v_and_b32 v10, v58, v6
  v_and_b32 v11, v58, v7
  v_and_b32 v12, v58, v8
  v_and_b32 v13, v58, v9
  v_and_b32 v14, v59, v6
  v_and_b32 v15, v59, v7
  v_and_b32 v16, v59, v8
  v_and_b32 v17, v59, v9
  s_nop 0
  v_mfma_f32_16x16x32_bf16 v[18:21], v[10:13], a[32:35], v[18:21]
  v_mfma_f32_16x16x32_bf16 v[22:25], v[14:17], a[32:35], v[22:25]
  v_and_b32 v10, v60, v6
  v_and_b32 v11, v60, v7
  v_and_b32 v12, v60, v8
  v_and_b32 v13, v60, v9
  v_and_b32 v14, v61, v6
  v_and_b32 v15, v61, v7
  v_and_b32 v16, v61, v8
  v_and_b32 v17, v61, v9
  s_nop 0
  v_mfma_f32_16x16x32_bf16 v[18:21], v[10:13], a[36:39], v[18:21]
  v_mfma_f32_16x16x32_bf16 v[22:25], v[14:17], a[36:39], v[22:25]
L_qshort:
  s_add_u32 s80, s15, 5
  s_and_b32 s80, s80, 31
  s_mul_i32 s80, s80, 49152
  buffer_load_dwordx4 v[148:151], v2, s[28:31], s80 offen offset:0 nt
  buffer_load_dwordx4 v[152:155], v2, s[28:31], s80 offen offset:128 nt
  buffer_load_dwordx4 v[156:159], v2, s[28:31], s80 offen offset:256 nt
  v_and_b32 v83, 31, v1
  v_lshlrev_b32 v83, 4, v83
  v_bfe_u32 v85, v1, 4, 1
  v_mul_u32_u24 v85, 3072, v85
  v_and_b32 v86, 15, v1
  v_lshl_add_u32 v85, v86, 4, v85
  v_lshrrev_b32 v86, 5, v1
  v_mul_u32_u24 v86, 768, v86
  v_add_u32 v85, v85, v86
  s_mul_i32 s81, s3, 6144
  s_mul_i32 s82, s54, 1536
  s_add_u32 s81, s81, s82
  s_lshl_b32 s82, s55, 8
  s_add_u32 s81, s81, s82
  s_mov_b64 exec, s[86:87]
  ds_write_b128 v81, v[18:21] offset:5120
  ds_write_b128 v81, v[22:25] offset:5376
  s_mov_b64 exec, -1
  s_waitcnt lgkmcnt(0)
  s_barrier
  s_cmp_lg_u32 s72, 0
  s_cbranch_scc1 L_rdone
  ds_read_b128 v[42:45], v83 offset:5120
  ds_read_b128 v[46:49], v83 offset:5648
  ds_read_b128 v[50:53], v83 offset:6176
  ds_read_b128 v[54:57], v83 offset:6704
  ds_read_b128 v[58:61], v83 offset:7232
  ds_read_b128 v[62:65], v83 offset:7760
  ds_read_b128 v[66:69], v83 offset:8288
  ds_read_b128 v[70:73], v83 offset:8816
  s_waitcnt lgkmcnt(6)
  v_add_f32 v18, v42, v46
  v_add_f32 v19, v43, v47
  v_add_f32 v20, v44, v48
  v_add_f32 v21, v45, v49
  s_waitcnt lgkmcnt(5)
  v_add_f32 v18, v18, v50
  v_add_f32 v19, v19, v51
  v_add_f32 v20, v20, v52
  v_add_f32 v21, v21, v53
  s_waitcnt lgkmcnt(4)
  v_add_f32 v18, v18, v54
  v_add_f32 v19, v19, v55
  v_add_f32 v20, v20, v56
  v_add_f32 v21, v21, v57
  s_waitcnt lgkmcnt(3)
  v_add_f32 v18, v18, v58
  v_add_f32 v19, v19, v59
  v_add_f32 v20, v20, v60
  v_add_f32 v21, v21, v61
  s_waitcnt lgkmcnt(2)
  v_add_f32 v18, v18, v62
  v_add_f32 v19, v19, v63
  v_add_f32 v20, v20, v64
  v_add_f32 v21, v21, v65
  s_waitcnt lgkmcnt(1)
  v_add_f32 v18, v18, v66
  v_add_f32 v19, v19, v67
  v_add_f32 v20, v20, v68
  v_add_f32 v21, v21, v69
  s_waitcnt lgkmcnt(0)
  v_add_f32 v18, v18, v70
  v_add_f32 v19, v19, v71
  v_add_f32 v20, v20, v72
  v_add_f32 v21, v21, v73
  s_mov_b32 exec_lo, 0
  v_and_b32 v22, 0xffffff00, v18
  v_and_b32 v23, 0xffffff00, v19
  v_and_b32 v24, 0xffffff00, v20
  v_and_b32 v25, 0xffffff00, v21
  v_sub_f32 v18, v18, v22
  v_sub_f32 v19, v19, v23
  v_sub_f32 v20, v20, v24
  v_sub_f32 v21, v21, v25
  s_mov_b64 exec, -1
  v_perm_b32 v18, v76, v18, s16
  v_perm_b32 v19, v76, v19, s17
  v_perm_b32 v20, v76, v20, s18
  v_perm_b32 v21, v76, v21, s19
  buffer_store_dwordx4 v[18:21], v85, s[60:63], s81 offen sc1
  s_branch L_rdone
L_frole:
  v_bfe_u32 v82, v1, 3, 1
  v_mul_u32_u24 v82, 2560, v82
  v_lshrrev_b32 v85, 4, v1
  v_lshl_add_u32 v82, v85, 2, v82
  s_lshl_b32 s81, s77, 9
  s_lshl_b32 s82, s72, 4
  s_add_u32 s81, s81, s82
  v_add_u32 v82, s81, v82
  ds_read2_b32 v[42:43], v82 offset0:0 offset1:16
  ds_read2_b32 v[44:45], v82 offset0:32 offset1:48
  ds_read2_b32 v[46:47], v82 offset0:64 offset1:80
  ds_read2_b32 v[48:49], v82 offset0:96 offset1:112
  s_waitcnt lgkmcnt(0)
  v_and_b32 v10, v42, v6
  v_and_b32 v11, v42, v7
  v_and_b32 v12, v42, v8
  v_and_b32 v13, v42, v9
  s_nop 0
  s_waitcnt vmcnt(19)
  v_mfma_f32_16x16x32_bf16 v[18:21], v[10:13], a[0:3], 0
  v_mfma_f32_16x16x32_bf16 v[22:25], v[10:13], a[4:7], 0
  v_and_b32 v14, v43, v6
  v_and_b32 v15, v43, v7
  v_and_b32 v16, v43, v8
  v_and_b32 v17, v43, v9
  s_nop 0
  s_nop 0
  v_mfma_f32_16x16x32_bf16 v[18:21], v[14:17], a[8:11], v[18:21]
  v_mfma_f32_16x16x32_bf16 v[22:25], v[14:17], a[12:15], v[22:25]
  v_and_b32 v10, v44, v6
  v_and_b32 v11, v44, v7
  v_and_b32 v12, v44, v8
  v_and_b32 v13, v44, v9
  s_nop 0
  s_nop 0
  v_mfma_f32_16x16x32_bf16 v[18:21], v[10:13], a[16:19], v[18:21]
  v_mfma_f32_16x16x32_bf16 v[22:25], v[10:13], a[20:23], v[22:25]
  v_and_b32 v14, v45, v6
  v_and_b32 v15, v45, v7
  v_and_b32 v16, v45, v8
  v_and_b32 v17, v45, v9
  s_nop 0
  s_nop 0
  v_mfma_f32_16x16x32_bf16 v[18:21], v[14:17], a[24:27], v[18:21]
  v_mfma_f32_16x16x32_bf16 v[22:25], v[14:17], a[28:31], v[22:25]
  v_and_b32 v10, v46, v6
  v_and_b32 v11, v46, v7
  v_and_b32 v12, v46, v8
  v_and_b32 v13, v46, v9
  s_nop 0
  s_nop 0
  v_mfma_f32_16x16x32_bf16 v[18:21], v[10:13], a[32:35], v[18:21]
  v_mfma_f32_16x16x32_bf16 v[22:25], v[10:13], a[36:39], v[22:25]
  v_and_b32 v14, v47, v6
  v_and_b32 v15, v47, v7
  v_and_b32 v16, v47, v8
  v_and_b32 v17, v47, v9
  s_nop 0
  s_nop 0
  v_mfma_f32_16x16x32_bf16 v[18:21], v[14:17], a[40:43], v[18:21]
  v_mfma_f32_16x16x32_bf16 v[22:25], v[14:17], a[44:47], v[22:25]
  v_and_b32 v10, v48, v6
  v_and_b32 v11, v48, v7
  v_and_b32 v12, v48, v8
  v_and_b32 v13, v48, v9
  s_nop 0
  s_nop 0
  v_mfma_f32_16x16x32_bf16 v[18:21], v[10:13], a[48:51], v[18:21]
  v_mfma_f32_16x16x32_bf16 v[22:25], v[10:13], a[52:55], v[22:25]
  v_and_b32 v14, v49, v6
  v_and_b32 v15, v49, v7
  v_and_b32 v16, v49, v8
  v_and_b32 v17, v49, v9
  s_nop 0
  s_nop 0
  v_mfma_f32_16x16x32_bf16 v[18:21], v[14:17], a[56:59], v[18:21]
  v_mfma_f32_16x16x32_bf16 v[22:25], v[14:17], a[60:63], v[22:25]
  s_add_u32 s80, s15, 5
  s_and_b32 s80, s80, 31
  s_mul_i32 s80, s80, 49152
  buffer_load_dwordx4 v[148:151], v2, s[28:31], s80 offen offset:0 nt
  buffer_load_dwordx4 v[152:155], v2, s[28:31], s80 offen offset:128 nt
  buffer_load_dwordx4 v[156:159], v2, s[28:31], s80 offen offset:256 nt
  s_lshl_b32 s81, s72, 11
  v_add_u32 v82, s81, v79
  v_bfe_u32 v84, v0, 1, 2
  v_lshlrev_b32 v84, 9, v84
  v_bfe_u32 v85, v0, 3, 4
  v_lshl_add_u32 v84, v85, 5, v84
  v_and_b32 v86, 1, v0
  v_lshl_add_u32 v84, v86, 4, v84
  v_and_b32 v85, 127, v0
  v_lshlrev_b32 v85, 4, v85
  s_mul_i32 s81, s77, 24576
  s_lshl_b32 s82, s76, 11
  s_add_u32 s81, s81, s82
  s_add_u32 s81, s81, 196608
  ds_write_b128 v82, v[18:21] offset:24576
  ds_write_b128 v82, v[22:25] offset:25600
  s_waitcnt lgkmcnt(0)
  s_barrier
  s_cmp_eq_u32 s71, 0
  s_cbranch_scc1 L_rdone
  ds_read_b128 v[42:45], v84 offset:24576
  ds_read_b128 v[46:49], v84 offset:26624
  ds_read_b128 v[50:53], v84 offset:28672
  ds_read_b128 v[54:57], v84 offset:30720
  s_waitcnt lgkmcnt(0)
  v_add_f32 v18, v42, v46
  v_add_f32 v19, v43, v47
  v_add_f32 v20, v44, v48
  v_add_f32 v21, v45, v49
  v_add_f32 v18, v18, v50
  v_add_f32 v19, v19, v51
  v_add_f32 v20, v20, v52
  v_add_f32 v21, v21, v53
  v_add_f32 v18, v18, v54
  v_add_f32 v19, v19, v55
  v_add_f32 v20, v20, v56
  v_add_f32 v21, v21, v57
  s_cmp_ge_u32 s72, 2
  s_cbranch_scc1 L_rdone
  v_add_u32 v18, 0x80, v18
  v_perm_b32 v18, v76, v18, s16
  v_add_u32 v19, 0x80, v19
  v_perm_b32 v19, v76, v19, s17
  v_add_u32 v20, 0x80, v20
  v_perm_b32 v20, v76, v20, s18
  v_add_u32 v21, 0x80, v21
  v_perm_b32 v21, v76, v21, s19
  buffer_store_dwordx4 v[18:21], v85, s[60:63], s81 offen sc1
L_rdone:
  s_lshl_b32 s81, s74, 1
  s_add_u32 s81, s81, s73
  s_mul_i32 s81, s81, 3072
  s_mul_i32 s82, s72, 768
  s_add_u32 s81, s81, s82
  v_lshlrev_b32 v86, 4, v1
  v_add_u32 v3, s81, v86
  s_add_u32 s80, s15, 6
  s_and_b32 s80, s80, 31
  s_mul_i32 s80, s80, 49152
  buffer_load_dwordx4 v[160:163], v2, s[28:31], s80 offen offset:0 nt
  buffer_load_dwordx4 v[164:167], v2, s[28:31], s80 offen offset:128 nt
  buffer_load_dwordx4 v[168:171], v2, s[28:31], s80 offen offset:256 nt
  s_add_u32 s80, s15, 7
  s_and_b32 s80, s80, 31
  s_mul_i32 s80, s80, 49152
  buffer_load_dwordx4 v[172:175], v2, s[28:31], s80 offen offset:0 nt
  buffer_load_dwordx4 v[176:179], v2, s[28:31], s80 offen offset:128 nt
  buffer_load_dwordx4 v[180:183], v2, s[28:31], s80 offen offset:256 nt
  s_add_u32 s80, s15, 8
  s_and_b32 s80, s80, 31
  s_mul_i32 s80, s80, 49152
  buffer_load_dwordx4 v[184:187], v2, s[28:31], s80 offen offset:0 nt
  buffer_load_dwordx4 v[188:191], v2, s[28:31], s80 offen offset:128 nt
  buffer_load_dwordx4 v[192:195], v2, s[28:31], s80 offen offset:256 nt
  s_add_u32 s80, s15, 9
  s_and_b32 s80, s80, 31
  s_mul_i32 s80, s80, 49152
  buffer_load_dwordx4 v[196:199], v2, s[28:31], s80 offen offset:0 nt
  buffer_load_dwordx4 v[200:203], v2, s[28:31], s80 offen offset:128 nt
  buffer_load_dwordx4 v[204:207], v2, s[28:31], s80 offen offset:256 nt
  s_add_u32 s80, s15, 10
  s_and_b32 s80, s80, 31
  s_mul_i32 s80, s80, 49152
  buffer_load_dwordx4 v[208:211], v2, s[28:31], s80 offen offset:0 nt
  buffer_load_dwordx4 v[212:215], v2, s[28:31], s80 offen offset:128 nt
  buffer_load_dwordx4 v[216:219], v2, s[28:31], s80 offen offset:256 nt
  s_add_u32 s80, s15, 11
  s_and_b32 s80, s80, 31
  s_mul_i32 s80, s80, 49152
  buffer_load_dwordx4 v[220:223], v2, s[28:31], s80 offen offset:0 nt
  buffer_load_dwordx4 v[224:227], v2, s[28:31], s80 offen offset:128 nt
  buffer_load_dwordx4 v[228:231], v2, s[28:31], s80 offen offset:256 nt
  s_mov_b32 exec_hi, 0xffff
  buffer_load_dwordx4 v[42:45], v3, s[60:63], 0 offen sc1
  s_mov_b64 exec, -1
  s_add_u32 s80, s15, 12
  s_and_b32 s80, s80, 31
  s_mul_i32 s80, s80, 49152
  buffer_load_dwordx4 v[232:235], v2, s[28:31], s80 offen offset:0 nt
  buffer_load_dwordx4 v[236:239], v2, s[28:31], s80 offen offset:128 nt
  buffer_load_dwordx4 v[240:243], v2, s[28:31], s80 offen offset:256 nt
  s_add_u32 s80, s15, 13
  s_and_b32 s80, s80, 31
  s_mul_i32 s80, s80, 49152
  buffer_load_dwordx4 v[244:247], v2, s[28:31], s80 offen offset:0 nt
  buffer_load_dwordx4 v[248:251], v2, s[28:31], s80 offen offset:128 nt
  buffer_load_dwordx4 v[252:255], v2, s[28:31], s80 offen offset:256 nt
  s_add_u32 s80, s15, 0
  s_and_b32 s80, s80, 31
  s_mul_i32 s80, s80, 49152
  buffer_load_dwordx4 a[204:207], v2, s[32:35], s80 offen offset:0 nt
  buffer_load_dwordx4 a[208:211], v2, s[32:35], s80 offen offset:128 nt
  buffer_load_dwordx4 a[212:215], v2, s[32:35], s80 offen offset:256 nt
  s_add_u32 s80, s15, 1
  s_and_b32 s80, s80, 31
  s_mul_i32 s80, s80, 49152
  buffer_load_dwordx4 a[216:219], v2, s[32:35], s80 offen offset:0 nt
  buffer_load_dwordx4 a[220:223], v2, s[32:35], s80 offen offset:128 nt
  buffer_load_dwordx4 a[224:227], v2, s[32:35], s80 offen offset:256 nt
  s_add_u32 s80, s15, 2
  s_and_b32 s80, s80, 31
  s_mul_i32 s80, s80, 49152
  buffer_load_dwordx4 a[228:231], v2, s[32:35], s80 offen offset:0 nt
  buffer_load_dwordx4 a[232:235], v2, s[32:35], s80 offen offset:128 nt
  buffer_load_dwordx4 a[236:239], v2, s[32:35], s80 offen offset:256 nt
  v_mov_b32 v46, 0
  v_mov_b32 v47, 0
  v_mov_b32 v48, 0
  v_mov_b32 v49, 0
  v_mov_b32 v50, 0
  v_mov_b32 v51, 0
  v_mov_b32 v52, 0
  v_mov_b32 v53, 0
  v_mov_b32 v54, 0
  v_mov_b32 v55, 0
  v_mov_b32 v56, 0
  v_mov_b32 v57, 0
  v_mov_b32 v58, 0
  v_mov_b32 v59, 0
  v_mov_b32 v60, 0
  v_mov_b32 v61, 0
  v_mov_b32 v62, 0
  v_mov_b32 v63, 0
  v_mov_b32 v64, 0
  v_mov_b32 v65, 0
  v_mov_b32 v66, 0
  v_mov_b32 v67, 0
  v_mov_b32 v68, 0
  v_mov_b32 v69, 0
  v_mov_b32 v70, 0
  v_mov_b32 v71, 0
  v_mov_b32 v72, 0
  v_mov_b32 v73, 0
  s_mul_i32 s81, s72, 768
  s_add_u32 s81, s81, 9472
  v_lshlrev_b32 v84, 3, v1
  v_add_u32 v85, s81, v86
  v_and_b32 v87, 7, v1
  v_lshlrev_b32 v87, 4, v87
  s_waitcnt vmcnt(15)
  s_mov_b32 exec_hi, 0xffff
  s_mov_b32 s88, 65536
L_qcloop_2:
  v_perm_b32 v82, v43, v42, s14
  v_perm_b32 v83, v45, v44, s14
  v_lshl_or_b32 v82, v83, 16, v82
  v_cmp_ne_u32 vcc, v82, v76
  s_nop 4
  s_cbranch_vccz L_qcok_1
  s_sub_u32 s88, s88, 1
  s_cbranch_scc1 L_qcok_1
  s_sleep 4
  buffer_load_dwordx4 v[42:45], v3, s[60:63], 0 offen sc1
  s_waitcnt vmcnt(0)
  s_branch L_qcloop_2
L_qcok_1:
  v_and_b32 v42, 0xffffff00, v42
  v_and_b32 v43, 0xffffff00, v43
  v_and_b32 v44, 0xffffff00, v44
  v_and_b32 v45, 0xffffff00, v45
  ds_write_b128 v85, v[42:45]
  s_mov_b64 exec, -1
  s_waitcnt lgkmcnt(0)
  s_barrier
  ds_read_b128 v[30:33], v86 offset:9472
  ds_read_b128 v[34:37], v86 offset:10240
  ds_read_b128 v[38:41], v86 offset:11008
  ds_read_b128 v[10:13], v86 offset:11776
  v_mov_b32 v42, 0
  v_mov_b32 v43, 0
  v_mov_b32 v44, 0
  v_mov_b32 v45, 0
  s_waitcnt lgkmcnt(0)
  v_add_f32 v30, v30, v34
  v_add_f32 v31, v31, v35
  v_add_f32 v32, v32, v36
  v_add_f32 v33, v33, v37
  v_add_f32 v38, v38, v10
  v_add_f32 v39, v39, v11
  v_add_f32 v40, v40, v12
  v_add_f32 v41, v41, v13
  v_add_f32 v30, v30, v38
  v_add_f32 v31, v31, v39
  v_add_f32 v32, v32, v40
  v_add_f32 v33, v33, v41
  v_cvt_pk_bf16_f32 v30, v30, v31
  v_cvt_pk_bf16_f32 v31, v32, v33
  ds_write_b64 v84, v[30:31] offset:24064
  s_waitcnt lgkmcnt(0)
  ds_read_b128 v[30:33], v87 offset:24064
  ds_read_b128 v[34:37], v87 offset:24192
  ds_read_b128 v[38:41], v87 offset:24320
  s_waitcnt lgkmcnt(0)
  s_waitcnt vmcnt(49)
  v_dot2c_f32_bf16 v42, v88, v30
  v_dot2c_f32_bf16 v42, v89, v31
  v_dot2c_f32_bf16 v42, v90, v32
  v_dot2c_f32_bf16 v42, v91, v33
  v_dot2c_f32_bf16 v42, v92, v34
  v_dot2c_f32_bf16 v42, v93, v35
  v_dot2c_f32_bf16 v42, v94, v36
  v_dot2c_f32_bf16 v42, v95, v37
  v_dot2c_f32_bf16 v42, v96, v38
  v_dot2c_f32_bf16 v42, v97, v39
  v_dot2c_f32_bf16 v42, v98, v40
  v_dot2c_f32_bf16 v42, v99, v41
  s_add_u32 s80, s15, 14
  s_and_b32 s80, s80, 31
  s_mul_i32 s80, s80, 49152
  buffer_load_dwordx4 v[88:91], v2, s[28:31], s80 offen offset:0 nt
  buffer_load_dwordx4 v[92:95], v2, s[28:31], s80 offen offset:128 nt
  buffer_load_dwordx4 v[96:99], v2, s[28:31], s80 offen offset:256 nt
  buffer_load_dwordx4 a[0:3], v4, s[40:43], 0 offen offset:0
  s_mov_b32 s80, 5120
  buffer_load_dwordx4 a[4:7], v4, s[40:43], s80 offen offset:0
  buffer_load_dwordx4 a[8:11], v4, s[40:43], 0 offen offset:256
  s_lshl_b32 s81, s79, 2
  s_add_u32 s81, s81, s72
  s_lshl_b32 s82, s81, 8
  s_add_u32 s82, s82, 196608
  v_and_b32 v81, 15, v1
  v_lshlrev_b32 v81, 4, v81
  v_add_u32 v81, s82, v81
  v_lshrrev_b32 v80, 4, v1
  v_mul_u32_u24 v80, 24576, v80
  v_add_u32 v80, v80, v81
  v_add_u32 v81, 98304, v81
  buffer_load_dwordx4 v[10:13], v80, s[92:95], 0 offen sc1
  buffer_load_dwordx4 v[14:17], v81, s[92:95], 0 offen sc1
  s_waitcnt vmcnt(54)
  v_dot2c_f32_bf16 v43, v100, v30
  v_dot2c_f32_bf16 v43, v101, v31
  v_dot2c_f32_bf16 v43, v102, v32
  v_dot2c_f32_bf16 v43, v103, v33
  v_dot2c_f32_bf16 v43, v104, v34
  v_dot2c_f32_bf16 v43, v105, v35
  v_dot2c_f32_bf16 v43, v106, v36
  v_dot2c_f32_bf16 v43, v107, v37
  v_dot2c_f32_bf16 v43, v108, v38
  v_dot2c_f32_bf16 v43, v109, v39
  v_dot2c_f32_bf16 v43, v110, v40
  v_dot2c_f32_bf16 v43, v111, v41
  s_add_u32 s80, s15, 15
  s_and_b32 s80, s80, 31
  s_mul_i32 s80, s80, 49152
  buffer_load_dwordx4 v[100:103], v2, s[28:31], s80 offen offset:0 nt
  buffer_load_dwordx4 v[104:107], v2, s[28:31], s80 offen offset:128 nt
  buffer_load_dwordx4 v[108:111], v2, s[28:31], s80 offen offset:256 nt
  s_waitcnt vmcnt(54)
  v_dot2c_f32_bf16 v44, v112, v30
  v_dot2c_f32_bf16 v44, v113, v31
  v_dot2c_f32_bf16 v44, v114, v32
  v_dot2c_f32_bf16 v44, v115, v33
  v_dot2c_f32_bf16 v44, v116, v34
  v_dot2c_f32_bf16 v44, v117, v35
  v_dot2c_f32_bf16 v44, v118, v36
  v_dot2c_f32_bf16 v44, v119, v37
  v_dot2c_f32_bf16 v44, v120, v38
  v_dot2c_f32_bf16 v44, v121, v39
  v_dot2c_f32_bf16 v44, v122, v40
  v_dot2c_f32_bf16 v44, v123, v41
  s_add_u32 s80, s15, 16
  s_and_b32 s80, s80, 31
  s_mul_i32 s80, s80, 49152
  buffer_load_dwordx4 v[112:115], v2, s[28:31], s80 offen offset:0 nt
  buffer_load_dwordx4 v[116:119], v2, s[28:31], s80 offen offset:128 nt
  buffer_load_dwordx4 v[120:123], v2, s[28:31], s80 offen offset:256 nt
  s_mov_b32 s80, 5120
  buffer_load_dwordx4 a[12:15], v4, s[40:43], s80 offen offset:256
  buffer_load_dwordx4 a[16:19], v4, s[40:43], 0 offen offset:512
  buffer_load_dwordx4 a[20:23], v4, s[40:43], s80 offen offset:512
  s_waitcnt vmcnt(57)
  v_dot2c_f32_bf16 v45, v124, v30
  v_dot2c_f32_bf16 v45, v125, v31
  v_dot2c_f32_bf16 v45, v126, v32
  v_dot2c_f32_bf16 v45, v127, v33
  v_dot2c_f32_bf16 v45, v128, v34
  v_dot2c_f32_bf16 v45, v129, v35
  v_dot2c_f32_bf16 v45, v130, v36
  v_dot2c_f32_bf16 v45, v131, v37
  v_dot2c_f32_bf16 v45, v132, v38
  v_dot2c_f32_bf16 v45, v133, v39
  v_dot2c_f32_bf16 v45, v134, v40
  v_dot2c_f32_bf16 v45, v135, v41
  s_add_u32 s80, s15, 17
  s_and_b32 s80, s80, 31
  s_mul_i32 s80, s80, 49152
  buffer_load_dwordx4 v[124:127], v2, s[28:31], s80 offen offset:0 nt
  buffer_load_dwordx4 v[128:131], v2, s[28:31], s80 offen offset:128 nt
  buffer_load_dwordx4 v[132:135], v2, s[28:31], s80 offen offset:256 nt
  v_add_f32_dpp v42, v42, v42 quad_perm:[1,0,3,2] row_mask:0xf bank_mask:0xf
  v_add_f32_dpp v43, v43, v43 quad_perm:[1,0,3,2] row_mask:0xf bank_mask:0xf
  s_nop 0
  v_add_f32_dpp v42, v42, v42 quad_perm:[2,3,0,1] row_mask:0xf bank_mask:0xf
  v_add_f32_dpp v43, v43, v43 quad_perm:[2,3,0,1] row_mask:0xf bank_mask:0xf
  s_nop 0
  v_add_f32_dpp v42, v42, v42 row_half_mirror row_mask:0xf bank_mask:0xf
  v_add_f32_dpp v43, v43, v43 row_half_mirror row_mask:0xf bank_mask:0xf
  s_nop 0
  v_cvt_pk_bf16_f32 v82, v42, v43
  v_lshlrev_b32 v42, 16, v82
  v_and_b32 v43, 0xffff0000, v82
  v_mul_f32 v42, 0x3d93cd3a, v42
  v_mul_f32 v43, 0x3d93cd3a, v43
  v_cvt_pk_bf16_f32 v82, v42, v43
  v_lshlrev_b32 v42, 16, v82
  v_and_b32 v43, 0xffff0000, v82
  v_max_f32 v74, v42, v43
  s_waitcnt vmcnt(57)
  v_dot2c_f32_bf16 v46, v136, v30
  v_dot2c_f32_bf16 v46, v137, v31
  v_dot2c_f32_bf16 v46, v138, v32
  v_dot2c_f32_bf16 v46, v139, v33
  v_dot2c_f32_bf16 v46, v140, v34
  v_dot2c_f32_bf16 v46, v141, v35
  v_dot2c_f32_bf16 v46, v142, v36
  v_dot2c_f32_bf16 v46, v143, v37
  v_dot2c_f32_bf16 v46, v144, v38
  v_dot2c_f32_bf16 v46, v145, v39
  v_dot2c_f32_bf16 v46, v146, v40
  v_dot2c_f32_bf16 v46, v147, v41
  s_add_u32 s80, s15, 18
  s_and_b32 s80, s80, 31
  s_mul_i32 s80, s80, 49152
  buffer_load_dwordx4 v[136:139], v2, s[28:31], s80 offen offset:0 nt
  buffer_load_dwordx4 v[140:143], v2, s[28:31], s80 offen offset:128 nt
  buffer_load_dwordx4 v[144:147], v2, s[28:31], s80 offen offset:256 nt
  buffer_load_dwordx4 a[24:27], v4, s[40:43], 0 offen offset:768
  s_mov_b32 s80, 5120
  buffer_load_dwordx4 a[28:31], v4, s[40:43], s80 offen offset:768
  buffer_load_dwordx4 a[32:35], v4, s[40:43], 0 offen offset:1024
  s_waitcnt vmcnt(60)
  v_dot2c_f32_bf16 v47, v148, v30
  v_dot2c_f32_bf16 v47, v149, v31
  v_dot2c_f32_bf16 v47, v150, v32
  v_dot2c_f32_bf16 v47, v151, v33
  v_dot2c_f32_bf16 v47, v152, v34
  v_dot2c_f32_bf16 v47, v153, v35
  v_dot2c_f32_bf16 v47, v154, v36
  v_dot2c_f32_bf16 v47, v155, v37
  v_dot2c_f32_bf16 v47, v156, v38
  v_dot2c_f32_bf16 v47, v157, v39
  v_dot2c_f32_bf16 v47, v158, v40
  v_dot2c_f32_bf16 v47, v159, v41
  s_add_u32 s80, s15, 19
  s_and_b32 s80, s80, 31
  s_mul_i32 s80, s80, 49152
  buffer_load_dwordx4 v[148:151], v2, s[28:31], s80 offen offset:0 nt
  buffer_load_dwordx4 v[152:155], v2, s[28:31], s80 offen offset:128 nt
  buffer_load_dwordx4 v[156:159], v2, s[28:31], s80 offen offset:256 nt
  v_add_f32_dpp v44, v44, v44 quad_perm:[1,0,3,2] row_mask:0xf bank_mask:0xf
  v_add_f32_dpp v45, v45, v45 quad_perm:[1,0,3,2] row_mask:0xf bank_mask:0xf
  s_nop 0
  v_add_f32_dpp v44, v44, v44 quad_perm:[2,3,0,1] row_mask:0xf bank_mask:0xf
  v_add_f32_dpp v45, v45, v45 quad_perm:[2,3,0,1] row_mask:0xf bank_mask:0xf
  s_nop 0
  v_add_f32_dpp v44, v44, v44 row_half_mirror row_mask:0xf bank_mask:0xf
  v_add_f32_dpp v45, v45, v45 row_half_mirror row_mask:0xf bank_mask:0xf
  s_nop 0
  v_cvt_pk_bf16_f32 v82, v44, v45
  v_lshlrev_b32 v44, 16, v82
  v_and_b32 v45, 0xffff0000, v82
  v_mul_f32 v44, 0x3d93cd3a, v44
  v_mul_f32 v45, 0x3d93cd3a, v45
  v_cvt_pk_bf16_f32 v82, v44, v45
  v_lshlrev_b32 v44, 16, v82
  v_and_b32 v45, 0xffff0000, v82
  v_max3_f32 v74, v74, v44, v45
  s_waitcnt vmcnt(60)
  v_dot2c_f32_bf16 v48, v160, v30
  v_dot2c_f32_bf16 v48, v161, v31
  v_dot2c_f32_bf16 v48, v162, v32
  v_dot2c_f32_bf16 v48, v163, v33
  v_dot2c_f32_bf16 v48, v164, v34
  v_dot2c_f32_bf16 v48, v165, v35
  v_dot2c_f32_bf16 v48, v166, v36
  v_dot2c_f32_bf16 v48, v167, v37
  v_dot2c_f32_bf16 v48, v168, v38
  v_dot2c_f32_bf16 v48, v169, v39
  v_dot2c_f32_bf16 v48, v170, v40
  v_dot2c_f32_bf16 v48, v171, v41
  s_add_u32 s80, s15, 20
  s_and_b32 s80, s80, 31
  s_mul_i32 s80, s80, 49152
  buffer_load_dwordx4 v[160:163], v2, s[28:31], s80 offen offset:0 nt
  buffer_load_dwordx4 v[164:167], v2, s[28:31], s80 offen offset:128 nt
  buffer_load_dwordx4 v[168:171], v2, s[28:31], s80 offen offset:256 nt
  s_mov_b32 s80, 5120
  buffer_load_dwordx4 a[36:39], v4, s[40:43], s80 offen offset:1024
  s_mov_b32 s80, 10240
  buffer_load_dwordx4 a[40:43], v4, s[40:43], s80 offen offset:0
  s_mov_b32 s80, 15360
  buffer_load_dwordx4 a[44:47], v4, s[40:43], s80 offen offset:0
  s_waitcnt vmcnt(63)
  v_dot2c_f32_bf16 v49, v172, v30
  v_dot2c_f32_bf16 v49, v173, v31
  v_dot2c_f32_bf16 v49, v174, v32
  v_dot2c_f32_bf16 v49, v175, v33
  v_dot2c_f32_bf16 v49, v176, v34
  v_dot2c_f32_bf16 v49, v177, v35
  v_dot2c_f32_bf16 v49, v178, v36
  v_dot2c_f32_bf16 v49, v179, v37
  v_dot2c_f32_bf16 v49, v180, v38
  v_dot2c_f32_bf16 v49, v181, v39
  v_dot2c_f32_bf16 v49, v182, v40
  v_dot2c_f32_bf16 v49, v183, v41
  s_add_u32 s80, s15, 21
  s_and_b32 s80, s80, 31
  s_mul_i32 s80, s80, 49152
  buffer_load_dwordx4 v[172:175], v2, s[28:31], s80 offen offset:0 nt
  buffer_load_dwordx4 v[176:179], v2, s[28:31], s80 offen offset:128 nt
  buffer_load_dwordx4 v[180:183], v2, s[28:31], s80 offen offset:256 nt
  v_add_f32_dpp v46, v46, v46 quad_perm:[1,0,3,2] row_mask:0xf bank_mask:0xf
  v_add_f32_dpp v47, v47, v47 quad_perm:[1,0,3,2] row_mask:0xf bank_mask:0xf
  s_nop 0
  v_add_f32_dpp v46, v46, v46 quad_perm:[2,3,0,1] row_mask:0xf bank_mask:0xf
  v_add_f32_dpp v47, v47, v47 quad_perm:[2,3,0,1] row_mask:0xf bank_mask:0xf
  s_nop 0
  v_add_f32_dpp v46, v46, v46 row_half_mirror row_mask:0xf bank_mask:0xf
  v_add_f32_dpp v47, v47, v47 row_half_mirror row_mask:0xf bank_mask:0xf
  s_nop 0
  v_cvt_pk_bf16_f32 v82, v46, v47
  v_lshlrev_b32 v46, 16, v82
  v_and_b32 v47, 0xffff0000, v82
  v_mul_f32 v46, 0x3d93cd3a, v46
  v_mul_f32 v47, 0x3d93cd3a, v47
  v_cvt_pk_bf16_f32 v82, v46, v47
  v_lshlrev_b32 v46, 16, v82
  v_and_b32 v47, 0xffff0000, v82
  v_max3_f32 v74, v74, v46, v47
  s_waitcnt vmcnt(63)
  v_dot2c_f32_bf16 v50, v184, v30
  v_dot2c_f32_bf16 v50, v185, v31
  v_dot2c_f32_bf16 v50, v186, v32
  v_dot2c_f32_bf16 v50, v187, v33
  v_dot2c_f32_bf16 v50, v188, v34
  v_dot2c_f32_bf16 v50, v189, v35
  v_dot2c_f32_bf16 v50, v190, v36
  v_dot2c_f32_bf16 v50, v191, v37
  v_dot2c_f32_bf16 v50, v192, v38
  v_dot2c_f32_bf16 v50, v193, v39
  v_dot2c_f32_bf16 v50, v194, v40
  v_dot2c_f32_bf16 v50, v195, v41
  s_add_u32 s80, s15, 22
  s_and_b32 s80, s80, 31
  s_mul_i32 s80, s80, 49152
  buffer_load_dwordx4 v[184:187], v2, s[28:31], s80 offen offset:0 nt
  buffer_load_dwordx4 v[188:191], v2, s[28:31], s80 offen offset:128 nt
  buffer_load_dwordx4 v[192:195], v2, s[28:31], s80 offen offset:256 nt
  s_mov_b32 s80, 10240
  buffer_load_dwordx4 a[48:51], v4, s[40:43], s80 offen offset:256
  s_mov_b32 s80, 15360
  buffer_load_dwordx4 a[52:55], v4, s[40:43], s80 offen offset:256
  s_mov_b32 s80, 10240
  buffer_load_dwordx4 a[56:59], v4, s[40:43], s80 offen offset:512
  s_cmp_eq_u32 s70, 0
  s_cbranch_scc1 L_nost2_3
  s_waitcnt vmcnt(36)
  s_mov_b32 s88, 65536
L_p1loop_5:
  v_perm_b32 v83, v11, v10, s14
  v_perm_b32 v84, v13, v12, s14
  v_lshl_or_b32 v83, v84, 16, v83
  v_cmp_ne_u32 vcc, v83, v76
  v_perm_b32 v83, v15, v14, s14
  v_perm_b32 v84, v17, v16, s14
  v_lshl_or_b32 v83, v84, 16, v83
  v_cmp_ne_u32 s[84:85], v83, v76
  s_nop 3
  s_or_b64 vcc, vcc, s[84:85]
  s_nop 4
  s_cbranch_vccz L_p1ok_4
  s_sub_u32 s88, s88, 1
  s_cbranch_scc1 L_p1ok_4
  s_sleep 4
  buffer_load_dwordx4 v[10:13], v80, s[92:95], 0 offen sc1
  buffer_load_dwordx4 v[14:17], v81, s[92:95], 0 offen sc1
  s_waitcnt vmcnt(0)
  s_branch L_p1loop_5
L_p1ok_4:
  v_and_b32 v10, 0xffffff00, v10
  v_and_b32 v11, 0xffffff00, v11
  v_and_b32 v12, 0xffffff00, v12
  v_and_b32 v13, 0xffffff00, v13
  v_and_b32 v14, 0xffffff00, v14
  v_and_b32 v15, 0xffffff00, v15
  v_and_b32 v16, 0xffffff00, v16
  v_and_b32 v17, 0xffffff00, v17
  s_mov_b64 exec, 0xffff
  v_add_f32 v10, v10, v14
  v_add_f32 v11, v11, v15
  v_add_f32 v12, v12, v16
  v_add_f32 v13, v13, v17
  s_mov_b64 exec, -1
  v_mov_b32 v14, v10
  v_mov_b32 v15, v11
  v_mov_b32 v16, v12
  v_mov_b32 v17, v13
  s_nop 0
  v_permlane16_swap_b32 v10, v14
  v_permlane16_swap_b32 v11, v15
  v_permlane16_swap_b32 v12, v16
  v_permlane16_swap_b32 v13, v17
  s_nop 0
  v_add_f32 v10, v10, v14
  v_add_f32 v11, v11, v15
  v_add_f32 v12, v12, v16
  v_add_f32 v13, v13, v17
  v_mov_b32 v14, v10
  v_mov_b32 v15, v11
  v_mov_b32 v16, v12
  v_mov_b32 v17, v13
  s_nop 0
  v_permlane32_swap_b32 v10, v14
  v_permlane32_swap_b32 v11, v15
  v_permlane32_swap_b32 v12, v16
  v_permlane32_swap_b32 v13, v17
  s_nop 0
  v_add_f32 v10, v10, v14
  v_add_f32 v11, v11, v15
  v_add_f32 v12, v12, v16
  v_add_f32 v13, v13, v17
  v_cvt_pk_bf16_f32 v14, v10, v11
  v_cvt_pk_bf16_f32 v15, v12, v13
  v_lshlrev_b32 v10, 16, v14
  v_and_b32 v11, 0xffff0000, v14
  v_lshlrev_b32 v12, 16, v15
  v_and_b32 v13, 0xffff0000, v15
  s_nop 0
  v_mov_b32_dpp v14, v10 row_shl:4 row_mask:0xf bank_mask:0xf
  v_mov_b32_dpp v15, v11 row_shl:4 row_mask:0xf bank_mask:0xf
  v_mov_b32_dpp v16, v12 row_shl:4 row_mask:0xf bank_mask:0xf
  v_mov_b32_dpp v17, v13 row_shl:4 row_mask:0xf bank_mask:0xf
  v_mul_f32 v18, v10, v10
  v_mul_f32 v19, v11, v11
  v_mul_f32 v20, v12, v12
  v_mul_f32 v21, v13, v13
  v_mul_f32 v18, 0x3d372713, v18
  v_mul_f32 v19, 0x3d372713, v19
  v_mul_f32 v20, 0x3d372713, v20
  v_mul_f32 v21, 0x3d372713, v21
  v_fma_f32 v18, v18, v10, v10
  v_fma_f32 v19, v19, v11, v11
  v_fma_f32 v20, v20, v12, v12
  v_fma_f32 v21, v21, v13, v13
  v_mul_f32 v18, 0xc0135761, v18
  v_mul_f32 v19, 0xc0135761, v19
  v_mul_f32 v20, 0xc0135761, v20
  v_mul_f32 v21, 0xc0135761, v21
  v_exp_f32 v18, v18
  v_exp_f32 v19, v19
  v_exp_f32 v20, v20
  v_exp_f32 v21, v21
  v_add_f32 v18, 1.0, v18
  v_add_f32 v19, 1.0, v19
  v_add_f32 v20, 1.0, v20
  v_add_f32 v21, 1.0, v21
  v_rcp_f32 v18, v18
  v_rcp_f32 v19, v19
  v_rcp_f32 v20, v20
  v_rcp_f32 v21, v21
  v_mul_f32 v18, v10, v18
  v_mul_f32 v19, v11, v19
  v_mul_f32 v20, v12, v20
  v_mul_f32 v21, v13, v21
  v_cvt_pk_bf16_f32 v10, v18, v19
  v_cvt_pk_bf16_f32 v11, v20, v21
  v_lshlrev_b32 v18, 16, v10
  v_and_b32 v19, 0xffff0000, v10
  v_lshlrev_b32 v20, 16, v11
  v_and_b32 v21, 0xffff0000, v11
  v_mul_f32 v18, v18, v14
  v_mul_f32 v19, v19, v15
  v_mul_f32 v20, v20, v16
  v_mul_f32 v21, v21, v17
  v_cvt_pk_bf16_f32 v28, v18, v19
  v_cvt_pk_bf16_f32 v29, v20, v21
  v_bfe_u32 v18, v1, 3, 1
  v_lshlrev_b32 v18, 3, v18
  ds_bpermute_b32 v10, v18, v28 offset:0
  ds_bpermute_b32 v14, v18, v29 offset:0
  ds_bpermute_b32 v11, v18, v28 offset:4
  ds_bpermute_b32 v15, v18, v29 offset:4
  ds_bpermute_b32 v12, v18, v28 offset:32
  ds_bpermute_b32 v16, v18, v29 offset:32
  ds_bpermute_b32 v13, v18, v28 offset:36
  ds_bpermute_b32 v17, v18, v29 offset:36
  v_lshrrev_b32 v19, 4, v1
  v_mul_u32_u24 v19, 0x0202, v19
  v_add_u32 v19, 0x0100, v19
  v_lshl_or_b32 v19, v19, 16, v19
  s_waitcnt lgkmcnt(0)
  v_perm_b32 v10, v14, v10, v19
  v_perm_b32 v11, v15, v11, v19
  v_perm_b32 v12, v16, v12, v19
  v_perm_b32 v13, v17, v13, v19
  v_and_b32 v20, v10, v6
  v_and_b32 v21, v10, v7
  v_and_b32 v22, v10, v8
  v_and_b32 v23, v10, v9
  s_nop 1
  v_mfma_f32_16x16x32_bf16 v[16:19], v[20:23], a[240:243], 0
  v_and_b32 v24, v11, v6
  v_and_b32 v25, v11, v7
  v_and_b32 v26, v11, v8
  v_and_b32 v27, v11, v9
  s_nop 1
  v_mfma_f32_16x16x32_bf16 v[16:19], v[24:27], a[244:247], v[16:19]
  v_and_b32 v20, v12, v6
  v_and_b32 v21, v12, v7
  v_and_b32 v22, v12, v8
  v_and_b32 v23, v12, v9
  s_nop 1
  v_mfma_f32_16x16x32_bf16 v[16:19], v[20:23], a[248:251], v[16:19]
  v_and_b32 v24, v13, v6
  v_and_b32 v25, v13, v7
  v_and_b32 v26, v13, v8
  v_and_b32 v27, v13, v9
  s_nop 1
  v_mfma_f32_16x16x32_bf16 v[16:19], v[24:27], a[252:255], v[16:19]
  s_lshl_b32 s81, s72, 10
  v_add_u32 v10, s81, v79
  v_mov_b32 v11, 36928
  v_mov_b32 v12, 1
  s_nop 5
  ds_write_b128 v10, v[16:19] offset:32768
  s_waitcnt lgkmcnt(0)
  s_mov_b64 exec, 1
  ds_add_rtn_u32 v12, v11, v12
  s_mov_b64 exec, -1
  s_waitcnt lgkmcnt(0)
  v_readfirstlane_b32 s81, v12
  s_nop 3
  s_cmp_lg_u32 s81, 3
  s_cbranch_scc1 L_nost2_3
  v_lshlrev_b32 v28, 4, v1
  ds_read_b128 v[10:13], v28 offset:32768
  ds_read_b128 v[14:17], v28 offset:33792
  ds_read_b128 v[18:21], v28 offset:34816
  ds_read_b128 v[22:25], v28 offset:35840
  v_lshrrev_b32 v28, 3, v1
  v_mul_u32_u24 v28, 3072, v28
  v_and_b32 v29, 7, v1
  v_lshl_add_u32 v28, v29, 4, v28
  s_mul_i32 s81, s78, 24576
  s_lshl_b32 s82, s79, 7
  s_add_u32 s81, s81, s82
  s_add_u32 s81, s81, 442368
  s_waitcnt lgkmcnt(0)
  v_add_f32 v10, v10, v14
  v_add_f32 v11, v11, v15
  v_add_f32 v12, v12, v16
  v_add_f32 v13, v13, v17
  v_add_f32 v10, v10, v18
  v_add_f32 v11, v11, v19
  v_add_f32 v12, v12, v20
  v_add_f32 v13, v13, v21
  v_add_f32 v10, v10, v22
  v_add_f32 v11, v11, v23
  v_add_f32 v12, v12, v24
  v_add_f32 v13, v13, v25
  v_add_u32 v10, 0x80, v10
  v_perm_b32 v10, v76, v10, s16
  v_add_u32 v11, 0x80, v11
  v_perm_b32 v11, v76, v11, s17
  v_add_u32 v12, 0x80, v12
  v_perm_b32 v12, v76, v12, s18
  v_add_u32 v13, 0x80, v13
  v_perm_b32 v13, v76, v13, s19
  buffer_store_dwordx4 v[10:13], v28, s[92:95], s81 offen sc1
  s_nop 1
L_nost2_3:
  s_waitcnt vmcnt(63)
  v_dot2c_f32_bf16 v51, v196, v30
  v_dot2c_f32_bf16 v51, v197, v31
  v_dot2c_f32_bf16 v51, v198, v32
  v_dot2c_f32_bf16 v51, v199, v33
  v_dot2c_f32_bf16 v51, v200, v34
  v_dot2c_f32_bf16 v51, v201, v35
  v_dot2c_f32_bf16 v51, v202, v36
  v_dot2c_f32_bf16 v51, v203, v37
  v_dot2c_f32_bf16 v51, v204, v38
  v_dot2c_f32_bf16 v51, v205, v39
  v_dot2c_f32_bf16 v51, v206, v40
  v_dot2c_f32_bf16 v51, v207, v41
  s_add_u32 s80, s15, 23
  s_and_b32 s80, s80, 31
  s_mul_i32 s80, s80, 49152
  buffer_load_dwordx4 v[196:199], v2, s[28:31], s80 offen offset:0 nt
  buffer_load_dwordx4 v[200:203], v2, s[28:31], s80 offen offset:128 nt
  buffer_load_dwordx4 v[204:207], v2, s[28:31], s80 offen offset:256 nt
  v_add_f32_dpp v48, v48, v48 quad_perm:[1,0,3,2] row_mask:0xf bank_mask:0xf
  v_add_f32_dpp v49, v49, v49 quad_perm:[1,0,3,2] row_mask:0xf bank_mask:0xf
  s_nop 0
  v_add_f32_dpp v48, v48, v48 quad_perm:[2,3,0,1] row_mask:0xf bank_mask:0xf
  v_add_f32_dpp v49, v49, v49 quad_perm:[2,3,0,1] row_mask:0xf bank_mask:0xf
  s_nop 0
  v_add_f32_dpp v48, v48, v48 row_half_mirror row_mask:0xf bank_mask:0xf
  v_add_f32_dpp v49, v49, v49 row_half_mirror row_mask:0xf bank_mask:0xf
  s_nop 0
  v_cvt_pk_bf16_f32 v82, v48, v49
  v_lshlrev_b32 v48, 16, v82
  v_and_b32 v49, 0xffff0000, v82
  v_mul_f32 v48, 0x3d93cd3a, v48
  v_mul_f32 v49, 0x3d93cd3a, v49
  v_cvt_pk_bf16_f32 v82, v48, v49
  v_lshlrev_b32 v48, 16, v82
  v_and_b32 v49, 0xffff0000, v82
  v_max3_f32 v74, v74, v48, v49
  s_waitcnt vmcnt(63)
  v_dot2c_f32_bf16 v52, v208, v30
  v_dot2c_f32_bf16 v52, v209, v31
  v_dot2c_f32_bf16 v52, v210, v32
  v_dot2c_f32_bf16 v52, v211, v33
  v_dot2c_f32_bf16 v52, v212, v34
  v_dot2c_f32_bf16 v52, v213, v35
  v_dot2c_f32_bf16 v52, v214, v36
  v_dot2c_f32_bf16 v52, v215, v37
  v_dot2c_f32_bf16 v52, v216, v38
  v_dot2c_f32_bf16 v52, v217, v39
  v_dot2c_f32_bf16 v52, v218, v40
  v_dot2c_f32_bf16 v52, v219, v41
  s_add_u32 s80, s15, 24
  s_and_b32 s80, s80, 31
  s_mul_i32 s80, s80, 49152
  buffer_load_dwordx4 v[208:211], v2, s[28:31], s80 offen offset:0 nt
  buffer_load_dwordx4 v[212:215], v2, s[28:31], s80 offen offset:128 nt
  buffer_load_dwordx4 v[216:219], v2, s[28:31], s80 offen offset:256 nt
  s_mov_b32 s80, 15360
  buffer_load_dwordx4 a[60:63], v4, s[40:43], s80 offen offset:512
  s_mov_b32 s80, 10240
  buffer_load_dwordx4 a[64:67], v4, s[40:43], s80 offen offset:768
  s_mov_b32 s80, 15360
  buffer_load_dwordx4 a[68:71], v4, s[40:43], s80 offen offset:768
  s_waitcnt vmcnt(63)
  v_dot2c_f32_bf16 v53, v220, v30
  v_dot2c_f32_bf16 v53, v221, v31
  v_dot2c_f32_bf16 v53, v222, v32
  v_dot2c_f32_bf16 v53, v223, v33
  v_dot2c_f32_bf16 v53, v224, v34
  v_dot2c_f32_bf16 v53, v225, v35
  v_dot2c_f32_bf16 v53, v226, v36
  v_dot2c_f32_bf16 v53, v227, v37
  v_dot2c_f32_bf16 v53, v228, v38
  v_dot2c_f32_bf16 v53, v229, v39
  v_dot2c_f32_bf16 v53, v230, v40
  v_dot2c_f32_bf16 v53, v231, v41
  s_add_u32 s80, s15, 25
  s_and_b32 s80, s80, 31
  s_mul_i32 s80, s80, 49152
  buffer_load_dwordx4 v[220:223], v2, s[28:31], s80 offen offset:0 nt
  buffer_load_dwordx4 v[224:227], v2, s[28:31], s80 offen offset:128 nt
  buffer_load_dwordx4 v[228:231], v2, s[28:31], s80 offen offset:256 nt
  v_add_f32_dpp v50, v50, v50 quad_perm:[1,0,3,2] row_mask:0xf bank_mask:0xf
  v_add_f32_dpp v51, v51, v51 quad_perm:[1,0,3,2] row_mask:0xf bank_mask:0xf
  s_nop 0
  v_add_f32_dpp v50, v50, v50 quad_perm:[2,3,0,1] row_mask:0xf bank_mask:0xf
  v_add_f32_dpp v51, v51, v51 quad_perm:[2,3,0,1] row_mask:0xf bank_mask:0xf
  s_nop 0
  v_add_f32_dpp v50, v50, v50 row_half_mirror row_mask:0xf bank_mask:0xf
  v_add_f32_dpp v51, v51, v51 row_half_mirror row_mask:0xf bank_mask:0xf
  s_nop 0
  v_cvt_pk_bf16_f32 v82, v50, v51
  v_lshlrev_b32 v50, 16, v82
  v_and_b32 v51, 0xffff0000, v82
  v_mul_f32 v50, 0x3d93cd3a, v50
  v_mul_f32 v51, 0x3d93cd3a, v51
  v_cvt_pk_bf16_f32 v82, v50, v51
  v_lshlrev_b32 v50, 16, v82
  v_and_b32 v51, 0xffff0000, v82
  v_max3_f32 v74, v74, v50, v51
  s_waitcnt vmcnt(63)
  v_dot2c_f32_bf16 v54, v232, v30
  v_dot2c_f32_bf16 v54, v233, v31
  v_dot2c_f32_bf16 v54, v234, v32
  v_dot2c_f32_bf16 v54, v235, v33
  v_dot2c_f32_bf16 v54, v236, v34
  v_dot2c_f32_bf16 v54, v237, v35
  v_dot2c_f32_bf16 v54, v238, v36
  v_dot2c_f32_bf16 v54, v239, v37
  v_dot2c_f32_bf16 v54, v240, v38
  v_dot2c_f32_bf16 v54, v241, v39
  v_dot2c_f32_bf16 v54, v242, v40
  v_dot2c_f32_bf16 v54, v243, v41
  s_add_u32 s80, s15, 26
  s_and_b32 s80, s80, 31
  s_mul_i32 s80, s80, 49152
  buffer_load_dwordx4 v[232:235], v2, s[28:31], s80 offen offset:0 nt
  buffer_load_dwordx4 v[236:239], v2, s[28:31], s80 offen offset:128 nt
  buffer_load_dwordx4 v[240:243], v2, s[28:31], s80 offen offset:256 nt
  s_mov_b32 s80, 10240
  buffer_load_dwordx4 a[72:75], v4, s[40:43], s80 offen offset:1024
  s_mov_b32 s80, 15360
  buffer_load_dwordx4 a[76:79], v4, s[40:43], s80 offen offset:1024
  s_mov_b32 s80, 20480
  buffer_load_dwordx4 a[80:83], v4, s[40:43], s80 offen offset:0
  s_waitcnt vmcnt(63)
  v_dot2c_f32_bf16 v55, v244, v30
  v_dot2c_f32_bf16 v55, v245, v31
  v_dot2c_f32_bf16 v55, v246, v32
  v_dot2c_f32_bf16 v55, v247, v33
  v_dot2c_f32_bf16 v55, v248, v34
  v_dot2c_f32_bf16 v55, v249, v35
  v_dot2c_f32_bf16 v55, v250, v36
  v_dot2c_f32_bf16 v55, v251, v37
  v_dot2c_f32_bf16 v55, v252, v38
  v_dot2c_f32_bf16 v55, v253, v39
  v_dot2c_f32_bf16 v55, v254, v40
  v_dot2c_f32_bf16 v55, v255, v41
  s_add_u32 s80, s15, 27
  s_and_b32 s80, s80, 31
  s_mul_i32 s80, s80, 49152
  buffer_load_dwordx4 v[244:247], v2, s[28:31], s80 offen offset:0 nt
  buffer_load_dwordx4 v[248:251], v2, s[28:31], s80 offen offset:128 nt
  buffer_load_dwordx4 v[252:255], v2, s[28:31], s80 offen offset:256 nt
  v_add_f32_dpp v52, v52, v52 quad_perm:[1,0,3,2] row_mask:0xf bank_mask:0xf
  v_add_f32_dpp v53, v53, v53 quad_perm:[1,0,3,2] row_mask:0xf bank_mask:0xf
  s_nop 0
  v_add_f32_dpp v52, v52, v52 quad_perm:[2,3,0,1] row_mask:0xf bank_mask:0xf
  v_add_f32_dpp v53, v53, v53 quad_perm:[2,3,0,1] row_mask:0xf bank_mask:0xf
  s_nop 0
  v_add_f32_dpp v52, v52, v52 row_half_mirror row_mask:0xf bank_mask:0xf
  v_add_f32_dpp v53, v53, v53 row_half_mirror row_mask:0xf bank_mask:0xf
  s_nop 0
  v_cvt_pk_bf16_f32 v82, v52, v53
  v_lshlrev_b32 v52, 16, v82
  v_and_b32 v53, 0xffff0000, v82
  v_mul_f32 v52, 0x3d93cd3a, v52
  v_mul_f32 v53, 0x3d93cd3a, v53
  v_cvt_pk_bf16_f32 v82, v52, v53
  v_lshlrev_b32 v52, 16, v82
  v_and_b32 v53, 0xffff0000, v82
  v_max3_f32 v74, v74, v52, v53
  s_waitcnt vmcnt(62)
  v_dot2c_f32_bf16 v56, v88, v30
  v_dot2c_f32_bf16 v56, v89, v31
  v_dot2c_f32_bf16 v56, v90, v32
  v_dot2c_f32_bf16 v56, v91, v33
  v_dot2c_f32_bf16 v56, v92, v34
  v_dot2c_f32_bf16 v56, v93, v35
  v_dot2c_f32_bf16 v56, v94, v36
  v_dot2c_f32_bf16 v56, v95, v37
  v_dot2c_f32_bf16 v56, v96, v38
  v_dot2c_f32_bf16 v56, v97, v39
  v_dot2c_f32_bf16 v56, v98, v40
  v_dot2c_f32_bf16 v56, v99, v41
  s_add_u32 s80, s15, 28
  s_and_b32 s80, s80, 31
  s_mul_i32 s80, s80, 49152
  buffer_load_dwordx4 v[88:91], v2, s[28:31], s80 offen offset:0 nt
  buffer_load_dwordx4 v[92:95], v2, s[28:31], s80 offen offset:128 nt
  buffer_load_dwordx4 v[96:99], v2, s[28:31], s80 offen offset:256 nt
  s_mov_b32 s80, 25600
  buffer_load_dwordx4 a[84:87], v4, s[40:43], s80 offen offset:0
  s_mov_b32 s80, 20480
  buffer_load_dwordx4 a[88:91], v4, s[40:43], s80 offen offset:256
  s_mov_b32 s80, 25600
  buffer_load_dwordx4 a[92:95], v4, s[40:43], s80 offen offset:256
  s_waitcnt vmcnt(60)
  v_dot2c_f32_bf16 v57, v100, v30
  v_dot2c_f32_bf16 v57, v101, v31
  v_dot2c_f32_bf16 v57, v102, v32
  v_dot2c_f32_bf16 v57, v103, v33
  v_dot2c_f32_bf16 v57, v104, v34
  v_dot2c_f32_bf16 v57, v105, v35
  v_dot2c_f32_bf16 v57, v106, v36
  v_dot2c_f32_bf16 v57, v107, v37
  v_dot2c_f32_bf16 v57, v108, v38
  v_dot2c_f32_bf16 v57, v109, v39
  v_dot2c_f32_bf16 v57, v110, v40
  v_dot2c_f32_bf16 v57, v111, v41
  s_add_u32 s80, s15, 29
  s_and_b32 s80, s80, 31
  s_mul_i32 s80, s80, 49152
  buffer_load_dwordx4 v[100:103], v2, s[28:31], s80 offen offset:0 nt
  buffer_load_dwordx4 v[104:107], v2, s[28:31], s80 offen offset:128 nt
  buffer_load_dwordx4 v[108:111], v2, s[28:31], s80 offen offset:256 nt
  v_add_f32_dpp v54, v54, v54 quad_perm:[1,0,3,2] row_mask:0xf bank_mask:0xf
  v_add_f32_dpp v55, v55, v55 quad_perm:[1,0,3,2] row_mask:0xf bank_mask:0xf
  s_nop 0
  v_add_f32_dpp v54, v54, v54 quad_perm:[2,3,0,1] row_mask:0xf bank_mask:0xf
  v_add_f32_dpp v55, v55, v55 quad_perm:[2,3,0,1] row_mask:0xf bank_mask:0xf
  s_nop 0
  v_add_f32_dpp v54, v54, v54 row_half_mirror row_mask:0xf bank_mask:0xf
  v_add_f32_dpp v55, v55, v55 row_half_mirror row_mask:0xf bank_mask:0xf
  s_nop 0
  v_cvt_pk_bf16_f32 v82, v54, v55
  v_lshlrev_b32 v54, 16, v82
  v_and_b32 v55, 0xffff0000, v82
  v_mul_f32 v54, 0x3d93cd3a, v54
  v_mul_f32 v55, 0x3d93cd3a, v55
  v_cvt_pk_bf16_f32 v82, v54, v55
  v_lshlrev_b32 v54, 16, v82
  v_and_b32 v55, 0xffff0000, v82
  v_max3_f32 v74, v74, v54, v55
  s_waitcnt vmcnt(60)
  v_dot2c_f32_bf16 v58, v112, v30
  v_dot2c_f32_bf16 v58, v113, v31
  v_dot2c_f32_bf16 v58, v114, v32
  v_dot2c_f32_bf16 v58, v115, v33
  v_dot2c_f32_bf16 v58, v116, v34
  v_dot2c_f32_bf16 v58, v117, v35
  v_dot2c_f32_bf16 v58, v118, v36
  v_dot2c_f32_bf16 v58, v119, v37
  v_dot2c_f32_bf16 v58, v120, v38
  v_dot2c_f32_bf16 v58, v121, v39
  v_dot2c_f32_bf16 v58, v122, v40
  v_dot2c_f32_bf16 v58, v123, v41
  s_add_u32 s80, s15, 30
  s_and_b32 s80, s80, 31
  s_mul_i32 s80, s80, 49152
  buffer_load_dwordx4 v[112:115], v2, s[28:31], s80 offen offset:0 nt
  buffer_load_dwordx4 v[116:119], v2, s[28:31], s80 offen offset:128 nt
  buffer_load_dwordx4 v[120:123], v2, s[28:31], s80 offen offset:256 nt
  s_mov_b32 s80, 20480
  buffer_load_dwordx4 a[96:99], v4, s[40:43], s80 offen offset:512
  s_mov_b32 s80, 25600
  buffer_load_dwordx4 a[100:103], v4, s[40:43], s80 offen offset:512
  s_mov_b32 s80, 20480
  buffer_load_dwordx4 a[104:107], v4, s[40:43], s80 offen offset:768
  s_waitcnt vmcnt(60)
  v_dot2c_f32_bf16 v59, v124, v30
  v_dot2c_f32_bf16 v59, v125, v31
  v_dot2c_f32_bf16 v59, v126, v32
  v_dot2c_f32_bf16 v59, v127, v33
  v_dot2c_f32_bf16 v59, v128, v34
  v_dot2c_f32_bf16 v59, v129, v35
  v_dot2c_f32_bf16 v59, v130, v36
  v_dot2c_f32_bf16 v59, v131, v37
  v_dot2c_f32_bf16 v59, v132, v38
  v_dot2c_f32_bf16 v59, v133, v39
  v_dot2c_f32_bf16 v59, v134, v40
  v_dot2c_f32_bf16 v59, v135, v41
  s_add_u32 s80, s15, 31
  s_and_b32 s80, s80, 31
  s_mul_i32 s80, s80, 49152
  buffer_load_dwordx4 v[124:127], v2, s[28:31], s80 offen offset:0 nt
  buffer_load_dwordx4 v[128:131], v2, s[28:31], s80 offen offset:128 nt
  buffer_load_dwordx4 v[132:135], v2, s[28:31], s80 offen offset:256 nt
  v_add_f32_dpp v56, v56, v56 quad_perm:[1,0,3,2] row_mask:0xf bank_mask:0xf
  v_add_f32_dpp v57, v57, v57 quad_perm:[1,0,3,2] row_mask:0xf bank_mask:0xf
  s_nop 0
  v_add_f32_dpp v56, v56, v56 quad_perm:[2,3,0,1] row_mask:0xf bank_mask:0xf
  v_add_f32_dpp v57, v57, v57 quad_perm:[2,3,0,1] row_mask:0xf bank_mask:0xf
  s_nop 0
  v_add_f32_dpp v56, v56, v56 row_half_mirror row_mask:0xf bank_mask:0xf
  v_add_f32_dpp v57, v57, v57 row_half_mirror row_mask:0xf bank_mask:0xf
  s_nop 0
  v_cvt_pk_bf16_f32 v82, v56, v57
  v_lshlrev_b32 v56, 16, v82
  v_and_b32 v57, 0xffff0000, v82
  v_mul_f32 v56, 0x3d93cd3a, v56
  v_mul_f32 v57, 0x3d93cd3a, v57
  v_cvt_pk_bf16_f32 v82, v56, v57
  v_lshlrev_b32 v56, 16, v82
  v_and_b32 v57, 0xffff0000, v82
  v_max3_f32 v74, v74, v56, v57
  s_waitcnt vmcnt(60)
  v_dot2c_f32_bf16 v60, v136, v30
  v_dot2c_f32_bf16 v60, v137, v31
  v_dot2c_f32_bf16 v60, v138, v32
  v_dot2c_f32_bf16 v60, v139, v33
  v_dot2c_f32_bf16 v60, v140, v34
  v_dot2c_f32_bf16 v60, v141, v35
  v_dot2c_f32_bf16 v60, v142, v36
  v_dot2c_f32_bf16 v60, v143, v37
  v_dot2c_f32_bf16 v60, v144, v38
  v_dot2c_f32_bf16 v60, v145, v39
  v_dot2c_f32_bf16 v60, v146, v40
  v_dot2c_f32_bf16 v60, v147, v41
  s_add_u32 s80, s15, 3
  s_and_b32 s80, s80, 31
  s_mul_i32 s80, s80, 49152
  buffer_load_dwordx4 v[136:139], v2, s[32:35], s80 offen offset:0 nt
  buffer_load_dwordx4 v[140:143], v2, s[32:35], s80 offen offset:128 nt
  buffer_load_dwordx4 v[144:147], v2, s[32:35], s80 offen offset:256 nt
  s_mov_b32 s80, 25600
  buffer_load_dwordx4 a[108:111], v4, s[40:43], s80 offen offset:768
  s_mov_b32 s80, 20480
  buffer_load_dwordx4 a[112:115], v4, s[40:43], s80 offen offset:1024
  s_mov_b32 s80, 25600
  buffer_load_dwordx4 a[116:119], v4, s[40:43], s80 offen offset:1024
  s_waitcnt vmcnt(60)
  v_dot2c_f32_bf16 v61, v148, v30
  v_dot2c_f32_bf16 v61, v149, v31
  v_dot2c_f32_bf16 v61, v150, v32
  v_dot2c_f32_bf16 v61, v151, v33
  v_dot2c_f32_bf16 v61, v152, v34
  v_dot2c_f32_bf16 v61, v153, v35
  v_dot2c_f32_bf16 v61, v154, v36
  v_dot2c_f32_bf16 v61, v155, v37
  v_dot2c_f32_bf16 v61, v156, v38
  v_dot2c_f32_bf16 v61, v157, v39
  v_dot2c_f32_bf16 v61, v158, v40
  v_dot2c_f32_bf16 v61, v159, v41
  s_add_u32 s80, s15, 4
  s_and_b32 s80, s80, 31
  s_mul_i32 s80, s80, 49152
  buffer_load_dwordx4 v[148:151], v2, s[32:35], s80 offen offset:0 nt
  buffer_load_dwordx4 v[152:155], v2, s[32:35], s80 offen offset:128 nt
  buffer_load_dwordx4 v[156:159], v2, s[32:35], s80 offen offset:256 nt
  v_add_f32_dpp v58, v58, v58 quad_perm:[1,0,3,2] row_mask:0xf bank_mask:0xf
  v_add_f32_dpp v59, v59, v59 quad_perm:[1,0,3,2] row_mask:0xf bank_mask:0xf
  s_nop 0
  v_add_f32_dpp v58, v58, v58 quad_perm:[2,3,0,1] row_mask:0xf bank_mask:0xf
  v_add_f32_dpp v59, v59, v59 quad_perm:[2,3,0,1] row_mask:0xf bank_mask:0xf
  s_nop 0
  v_add_f32_dpp v58, v58, v58 row_half_mirror row_mask:0xf bank_mask:0xf
  v_add_f32_dpp v59, v59, v59 row_half_mirror row_mask:0xf bank_mask:0xf
  s_nop 0
  v_cvt_pk_bf16_f32 v82, v58, v59
  v_lshlrev_b32 v58, 16, v82
  v_and_b32 v59, 0xffff0000, v82
  v_mul_f32 v58, 0x3d93cd3a, v58
  v_mul_f32 v59, 0x3d93cd3a, v59
  v_cvt_pk_bf16_f32 v82, v58, v59
  v_lshlrev_b32 v58, 16, v82
  v_and_b32 v59, 0xffff0000, v82
  v_max3_f32 v74, v74, v58, v59
  s_waitcnt vmcnt(60)
  v_dot2c_f32_bf16 v62, v160, v30
  v_dot2c_f32_bf16 v62, v161, v31
  v_dot2c_f32_bf16 v62, v162, v32
  v_dot2c_f32_bf16 v62, v163, v33
  v_dot2c_f32_bf16 v62, v164, v34
  v_dot2c_f32_bf16 v62, v165, v35
  v_dot2c_f32_bf16 v62, v166, v36
  v_dot2c_f32_bf16 v62, v167, v37
  v_dot2c_f32_bf16 v62, v168, v38
  v_dot2c_f32_bf16 v62, v169, v39
  v_dot2c_f32_bf16 v62, v170, v40
  v_dot2c_f32_bf16 v62, v171, v41
  s_add_u32 s80, s15, 5
  s_and_b32 s80, s80, 31
  s_mul_i32 s80, s80, 49152
  buffer_load_dwordx4 v[160:163], v2, s[32:35], s80 offen offset:0 nt
  buffer_load_dwordx4 v[164:167], v2, s[32:35], s80 offen offset:128 nt
  buffer_load_dwordx4 v[168:171], v2, s[32:35], s80 offen offset:256 nt
  s_mov_b32 s80, 30720
  buffer_load_dwordx4 a[120:123], v4, s[40:43], s80 offen offset:0
  s_mov_b32 s80, 35840
  buffer_load_dwordx4 a[124:127], v4, s[40:43], s80 offen offset:0
  s_mov_b32 s80, 30720
  buffer_load_dwordx4 a[128:131], v4, s[40:43], s80 offen offset:256
  s_waitcnt vmcnt(60)
  v_dot2c_f32_bf16 v63, v172, v30
  v_dot2c_f32_bf16 v63, v173, v31
  v_dot2c_f32_bf16 v63, v174, v32
  v_dot2c_f32_bf16 v63, v175, v33
  v_dot2c_f32_bf16 v63, v176, v34
  v_dot2c_f32_bf16 v63, v177, v35
  v_dot2c_f32_bf16 v63, v178, v36
  v_dot2c_f32_bf16 v63, v179, v37
  v_dot2c_f32_bf16 v63, v180, v38
  v_dot2c_f32_bf16 v63, v181, v39
  v_dot2c_f32_bf16 v63, v182, v40
  v_dot2c_f32_bf16 v63, v183, v41
  s_add_u32 s80, s15, 6
  s_and_b32 s80, s80, 31
  s_mul_i32 s80, s80, 49152
  buffer_load_dwordx4 v[172:175], v2, s[32:35], s80 offen offset:0 nt
  buffer_load_dwordx4 v[176:179], v2, s[32:35], s80 offen offset:128 nt
  buffer_load_dwordx4 v[180:183], v2, s[32:35], s80 offen offset:256 nt
  v_add_f32_dpp v60, v60, v60 quad_perm:[1,0,3,2] row_mask:0xf bank_mask:0xf
  v_add_f32_dpp v61, v61, v61 quad_perm:[1,0,3,2] row_mask:0xf bank_mask:0xf
  s_nop 0
  v_add_f32_dpp v60, v60, v60 quad_perm:[2,3,0,1] row_mask:0xf bank_mask:0xf
  v_add_f32_dpp v61, v61, v61 quad_perm:[2,3,0,1] row_mask:0xf bank_mask:0xf
  s_nop 0
  v_add_f32_dpp v60, v60, v60 row_half_mirror row_mask:0xf bank_mask:0xf
  v_add_f32_dpp v61, v61, v61 row_half_mirror row_mask:0xf bank_mask:0xf
  s_nop 0
  v_cvt_pk_bf16_f32 v82, v60, v61
  v_lshlrev_b32 v60, 16, v82
  v_and_b32 v61, 0xffff0000, v82
  v_mul_f32 v60, 0x3d93cd3a, v60
  v_mul_f32 v61, 0x3d93cd3a, v61
  v_cvt_pk_bf16_f32 v82, v60, v61
  v_lshlrev_b32 v60, 16, v82
  v_and_b32 v61, 0xffff0000, v82
  v_max3_f32 v74, v74, v60, v61
  s_waitcnt vmcnt(60)
  v_dot2c_f32_bf16 v64, v184, v30
  v_dot2c_f32_bf16 v64, v185, v31
  v_dot2c_f32_bf16 v64, v186, v32
  v_dot2c_f32_bf16 v64, v187, v33
  v_dot2c_f32_bf16 v64, v188, v34
  v_dot2c_f32_bf16 v64, v189, v35
  v_dot2c_f32_bf16 v64, v190, v36
  v_dot2c_f32_bf16 v64, v191, v37
  v_dot2c_f32_bf16 v64, v192, v38
  v_dot2c_f32_bf16 v64, v193, v39
  v_dot2c_f32_bf16 v64, v194, v40
  v_dot2c_f32_bf16 v64, v195, v41
  s_add_u32 s80, s15, 7
  s_and_b32 s80, s80, 31
  s_mul_i32 s80, s80, 49152
  buffer_load_dwordx4 v[184:187], v2, s[32:35], s80 offen offset:0 nt
  buffer_load_dwordx4 v[188:191], v2, s[32:35], s80 offen offset:128 nt
  buffer_load_dwordx4 v[192:195], v2, s[32:35], s80 offen offset:256 nt
  s_mov_b32 s80, 35840
  buffer_load_dwordx4 a[132:135], v4, s[40:43], s80 offen offset:256
  s_mov_b32 s80, 30720
  buffer_load_dwordx4 a[136:139], v4, s[40:43], s80 offen offset:512
  s_mov_b32 s80, 35840
  buffer_load_dwordx4 a[140:143], v4, s[40:43], s80 offen offset:512
  s_waitcnt vmcnt(60)
  v_dot2c_f32_bf16 v65, v196, v30
  v_dot2c_f32_bf16 v65, v197, v31
  v_dot2c_f32_bf16 v65, v198, v32
  v_dot2c_f32_bf16 v65, v199, v33
  v_dot2c_f32_bf16 v65, v200, v34
  v_dot2c_f32_bf16 v65, v201, v35
  v_dot2c_f32_bf16 v65, v202, v36
  v_dot2c_f32_bf16 v65, v203, v37
  v_dot2c_f32_bf16 v65, v204, v38
  v_dot2c_f32_bf16 v65, v205, v39
  v_dot2c_f32_bf16 v65, v206, v40
  v_dot2c_f32_bf16 v65, v207, v41
  s_add_u32 s80, s15, 8
  s_and_b32 s80, s80, 31
  s_mul_i32 s80, s80, 49152
  buffer_load_dwordx4 v[196:199], v2, s[32:35], s80 offen offset:0 nt
  buffer_load_dwordx4 v[200:203], v2, s[32:35], s80 offen offset:128 nt
  buffer_load_dwordx4 v[204:207], v2, s[32:35], s80 offen offset:256 nt
  v_add_f32_dpp v62, v62, v62 quad_perm:[1,0,3,2] row_mask:0xf bank_mask:0xf
  v_add_f32_dpp v63, v63, v63 quad_perm:[1,0,3,2] row_mask:0xf bank_mask:0xf
  s_nop 0
  v_add_f32_dpp v62, v62, v62 quad_perm:[2,3,0,1] row_mask:0xf bank_mask:0xf
  v_add_f32_dpp v63, v63, v63 quad_perm:[2,3,0,1] row_mask:0xf bank_mask:0xf
  s_nop 0
  v_add_f32_dpp v62, v62, v62 row_half_mirror row_mask:0xf bank_mask:0xf
  v_add_f32_dpp v63, v63, v63 row_half_mirror row_mask:0xf bank_mask:0xf
  s_nop 0
  v_cvt_pk_bf16_f32 v82, v62, v63
  v_lshlrev_b32 v62, 16, v82
  v_and_b32 v63, 0xffff0000, v82
  v_mul_f32 v62, 0x3d93cd3a, v62
  v_mul_f32 v63, 0x3d93cd3a, v63
  v_cvt_pk_bf16_f32 v82, v62, v63
  v_lshlrev_b32 v62, 16, v82
  v_and_b32 v63, 0xffff0000, v82
  v_max3_f32 v74, v74, v62, v63
  s_waitcnt vmcnt(60)
  v_dot2c_f32_bf16 v66, v208, v30
  v_dot2c_f32_bf16 v66, v209, v31
  v_dot2c_f32_bf16 v66, v210, v32
  v_dot2c_f32_bf16 v66, v211, v33
  v_dot2c_f32_bf16 v66, v212, v34
  v_dot2c_f32_bf16 v66, v213, v35
  v_dot2c_f32_bf16 v66, v214, v36
  v_dot2c_f32_bf16 v66, v215, v37
  v_dot2c_f32_bf16 v66, v216, v38
  v_dot2c_f32_bf16 v66, v217, v39
  v_dot2c_f32_bf16 v66, v218, v40
  v_dot2c_f32_bf16 v66, v219, v41
  s_add_u32 s80, s15, 9
  s_and_b32 s80, s80, 31
  s_mul_i32 s80, s80, 49152
  buffer_load_dwordx4 v[208:211], v2, s[32:35], s80 offen offset:0 nt
  buffer_load_dwordx4 v[212:215], v2, s[32:35], s80 offen offset:128 nt
  buffer_load_dwordx4 v[216:219], v2, s[32:35], s80 offen offset:256 nt
  s_mov_b32 s80, 30720
  buffer_load_dwordx4 a[144:147], v4, s[40:43], s80 offen offset:768
  s_mov_b32 s80, 35840
  buffer_load_dwordx4 a[148:151], v4, s[40:43], s80 offen offset:768
  s_mov_b32 s80, 30720
  buffer_load_dwordx4 a[152:155], v4, s[40:43], s80 offen offset:1024
  s_waitcnt vmcnt(60)
  v_dot2c_f32_bf16 v67, v220, v30
  v_dot2c_f32_bf16 v67, v221, v31
  v_dot2c_f32_bf16 v67, v222, v32
  v_dot2c_f32_bf16 v67, v223, v33
  v_dot2c_f32_bf16 v67, v224, v34
  v_dot2c_f32_bf16 v67, v225, v35
  v_dot2c_f32_bf16 v67, v226, v36
  v_dot2c_f32_bf16 v67, v227, v37
  v_dot2c_f32_bf16 v67, v228, v38
  v_dot2c_f32_bf16 v67, v229, v39
  v_dot2c_f32_bf16 v67, v230, v40
  v_dot2c_f32_bf16 v67, v231, v41
  s_add_u32 s80, s15, 10
  s_and_b32 s80, s80, 31
  s_mul_i32 s80, s80, 49152
  buffer_load_dwordx4 v[220:223], v2, s[32:35], s80 offen offset:0 nt
  buffer_load_dwordx4 v[224:227], v2, s[32:35], s80 offen offset:128 nt
  buffer_load_dwordx4 v[228:231], v2, s[32:35], s80 offen offset:256 nt
  v_add_f32_dpp v64, v64, v64 quad_perm:[1,0,3,2] row_mask:0xf bank_mask:0xf
  v_add_f32_dpp v65, v65, v65 quad_perm:[1,0,3,2] row_mask:0xf bank_mask:0xf
  s_nop 0
  v_add_f32_dpp v64, v64, v64 quad_perm:[2,3,0,1] row_mask:0xf bank_mask:0xf
  v_add_f32_dpp v65, v65, v65 quad_perm:[2,3,0,1] row_mask:0xf bank_mask:0xf
  s_nop 0
  v_add_f32_dpp v64, v64, v64 row_half_mirror row_mask:0xf bank_mask:0xf
  v_add_f32_dpp v65, v65, v65 row_half_mirror row_mask:0xf bank_mask:0xf
  s_nop 0
  v_cvt_pk_bf16_f32 v82, v64, v65
  v_lshlrev_b32 v64, 16, v82
  v_and_b32 v65, 0xffff0000, v82
  v_mul_f32 v64, 0x3d93cd3a, v64
  v_mul_f32 v65, 0x3d93cd3a, v65
  v_cvt_pk_bf16_f32 v82, v64, v65
  v_lshlrev_b32 v64, 16, v82
  v_and_b32 v65, 0xffff0000, v82
  v_max3_f32 v74, v74, v64, v65
  s_waitcnt vmcnt(60)
  v_dot2c_f32_bf16 v68, v232, v30
  v_dot2c_f32_bf16 v68, v233, v31
  v_dot2c_f32_bf16 v68, v234, v32
  v_dot2c_f32_bf16 v68, v235, v33
  v_dot2c_f32_bf16 v68, v236, v34
  v_dot2c_f32_bf16 v68, v237, v35
  v_dot2c_f32_bf16 v68, v238, v36
  v_dot2c_f32_bf16 v68, v239, v37
  v_dot2c_f32_bf16 v68, v240, v38
  v_dot2c_f32_bf16 v68, v241, v39
  v_dot2c_f32_bf16 v68, v242, v40
  v_dot2c_f32_bf16 v68, v243, v41
  s_add_u32 s80, s15, 11
  s_and_b32 s80, s80, 31
  s_mul_i32 s80, s80, 49152
  buffer_load_dwordx4 v[232:235], v2, s[32:35], s80 offen offset:0 nt
  buffer_load_dwordx4 v[236:239], v2, s[32:35], s80 offen offset:128 nt
  buffer_load_dwordx4 v[240:243], v2, s[32:35], s80 offen offset:256 nt
  s_mov_b32 s80, 35840
  buffer_load_dwordx4 a[156:159], v4, s[40:43], s80 offen offset:1024
  s_mov_b32 s80, 40960
  buffer_load_dwordx4 a[160:163], v4, s[40:43], s80 offen offset:0
  s_mov_b32 s80, 46080
  buffer_load_dwordx4 a[164:167], v4, s[40:43], s80 offen offset:0
  s_waitcnt vmcnt(60)
  v_dot2c_f32_bf16 v69, v244, v30
  v_dot2c_f32_bf16 v69, v245, v31
  v_dot2c_f32_bf16 v69, v246, v32
  v_dot2c_f32_bf16 v69, v247, v33
  v_dot2c_f32_bf16 v69, v248, v34
  v_dot2c_f32_bf16 v69, v249, v35
  v_dot2c_f32_bf16 v69, v250, v36
  v_dot2c_f32_bf16 v69, v251, v37
  v_dot2c_f32_bf16 v69, v252, v38
  v_dot2c_f32_bf16 v69, v253, v39
  v_dot2c_f32_bf16 v69, v254, v40
  v_dot2c_f32_bf16 v69, v255, v41
  s_add_u32 s80, s15, 12
  s_and_b32 s80, s80, 31
  s_mul_i32 s80, s80, 49152
  buffer_load_dwordx4 v[244:247], v2, s[32:35], s80 offen offset:0 nt
  buffer_load_dwordx4 v[248:251], v2, s[32:35], s80 offen offset:128 nt
  buffer_load_dwordx4 v[252:255], v2, s[32:35], s80 offen offset:256 nt
  v_add_f32_dpp v66, v66, v66 quad_perm:[1,0,3,2] row_mask:0xf bank_mask:0xf
  v_add_f32_dpp v67, v67, v67 quad_perm:[1,0,3,2] row_mask:0xf bank_mask:0xf
  s_nop 0
  v_add_f32_dpp v66, v66, v66 quad_perm:[2,3,0,1] row_mask:0xf bank_mask:0xf
  v_add_f32_dpp v67, v67, v67 quad_perm:[2,3,0,1] row_mask:0xf bank_mask:0xf
  s_nop 0
  v_add_f32_dpp v66, v66, v66 row_half_mirror row_mask:0xf bank_mask:0xf
  v_add_f32_dpp v67, v67, v67 row_half_mirror row_mask:0xf bank_mask:0xf
  s_nop 0
  v_cvt_pk_bf16_f32 v82, v66, v67
  v_lshlrev_b32 v66, 16, v82
  v_and_b32 v67, 0xffff0000, v82
  v_mul_f32 v66, 0x3d93cd3a, v66
  v_mul_f32 v67, 0x3d93cd3a, v67
  v_cvt_pk_bf16_f32 v82, v66, v67
  v_lshlrev_b32 v66, 16, v82
  v_and_b32 v67, 0xffff0000, v82
  v_max3_f32 v74, v74, v66, v67
  s_waitcnt vmcnt(60)
  v_dot2c_f32_bf16 v70, v88, v30
  v_dot2c_f32_bf16 v70, v89, v31
  v_dot2c_f32_bf16 v70, v90, v32
  v_dot2c_f32_bf16 v70, v91, v33
  v_dot2c_f32_bf16 v70, v92, v34
  v_dot2c_f32_bf16 v70, v93, v35
  v_dot2c_f32_bf16 v70, v94, v36
  v_dot2c_f32_bf16 v70, v95, v37
  v_dot2c_f32_bf16 v70, v96, v38
  v_dot2c_f32_bf16 v70, v97, v39
  v_dot2c_f32_bf16 v70, v98, v40
  v_dot2c_f32_bf16 v70, v99, v41
  s_add_u32 s80, s15, 13
  s_and_b32 s80, s80, 31
  s_mul_i32 s80, s80, 49152
  buffer_load_dwordx4 v[88:91], v2, s[32:35], s80 offen offset:0 nt
  buffer_load_dwordx4 v[92:95], v2, s[32:35], s80 offen offset:128 nt
  buffer_load_dwordx4 v[96:99], v2, s[32:35], s80 offen offset:256 nt
  s_mov_b32 s80, 40960
  buffer_load_dwordx4 a[168:171], v4, s[40:43], s80 offen offset:256
  s_mov_b32 s80, 46080
  buffer_load_dwordx4 a[172:175], v4, s[40:43], s80 offen offset:256
  s_mov_b32 s80, 40960
  buffer_load_dwordx4 a[176:179], v4, s[40:43], s80 offen offset:512
  s_waitcnt vmcnt(60)
  v_dot2c_f32_bf16 v71, v100, v30
  v_dot2c_f32_bf16 v71, v101, v31
  v_dot2c_f32_bf16 v71, v102, v32
  v_dot2c_f32_bf16 v71, v103, v33
  v_dot2c_f32_bf16 v71, v104, v34
  v_dot2c_f32_bf16 v71, v105, v35
  v_dot2c_f32_bf16 v71, v106, v36
  v_dot2c_f32_bf16 v71, v107, v37
  v_dot2c_f32_bf16 v71, v108, v38
  v_dot2c_f32_bf16 v71, v109, v39
  v_dot2c_f32_bf16 v71, v110, v40
  v_dot2c_f32_bf16 v71, v111, v41
  s_add_u32 s80, s15, 14
  s_and_b32 s80, s80, 31
  s_mul_i32 s80, s80, 49152
  buffer_load_dwordx4 v[100:103], v2, s[32:35], s80 offen offset:0 nt
  buffer_load_dwordx4 v[104:107], v2, s[32:35], s80 offen offset:128 nt
  buffer_load_dwordx4 v[108:111], v2, s[32:35], s80 offen offset:256 nt
  v_add_f32_dpp v68, v68, v68 quad_perm:[1,0,3,2] row_mask:0xf bank_mask:0xf
  v_add_f32_dpp v69, v69, v69 quad_perm:[1,0,3,2] row_mask:0xf bank_mask:0xf
  s_nop 0
  v_add_f32_dpp v68, v68, v68 quad_perm:[2,3,0,1] row_mask:0xf bank_mask:0xf
  v_add_f32_dpp v69, v69, v69 quad_perm:[2,3,0,1] row_mask:0xf bank_mask:0xf
  s_nop 0
  v_add_f32_dpp v68, v68, v68 row_half_mirror row_mask:0xf bank_mask:0xf
  v_add_f32_dpp v69, v69, v69 row_half_mirror row_mask:0xf bank_mask:0xf
  s_nop 0
  v_cvt_pk_bf16_f32 v82, v68, v69
  v_lshlrev_b32 v68, 16, v82
  v_and_b32 v69, 0xffff0000, v82
  v_mul_f32 v68, 0x3d93cd3a, v68
  v_mul_f32 v69, 0x3d93cd3a, v69
  v_cvt_pk_bf16_f32 v82, v68, v69
  v_lshlrev_b32 v68, 16, v82
  v_and_b32 v69, 0xffff0000, v82
  v_max3_f32 v74, v74, v68, v69
  v_mov_b32 v83, v74
  s_nop 1
  v_max_f32_dpp v83, v83, v83 row_ror:8 row_mask:0xf bank_mask:0xf
  v_mov_b32 v82, v83
  s_nop 1
  v_permlane16_swap_b32 v83, v82
  s_nop 1
  v_max_f32 v83, v83, v82
  v_mov_b32 v82, v83
  s_nop 1
  v_permlane32_swap_b32 v83, v82
  s_nop 1
  v_max_f32 v83, v83, v82
  v_sub_f32 v42, v42, v83
  v_sub_f32 v43, v43, v83
  v_sub_f32 v44, v44, v83
  v_sub_f32 v45, v45, v83
  v_sub_f32 v46, v46, v83
  v_sub_f32 v47, v47, v83
  v_sub_f32 v48, v48, v83
  v_sub_f32 v49, v49, v83
  v_sub_f32 v50, v50, v83
  v_sub_f32 v51, v51, v83
  v_sub_f32 v52, v52, v83
  v_sub_f32 v53, v53, v83
  v_sub_f32 v54, v54, v83
  v_sub_f32 v55, v55, v83
  v_mul_f32 v42, 0x3fb8aa3b, v42
  v_mul_f32 v43, 0x3fb8aa3b, v43
  v_mul_f32 v44, 0x3fb8aa3b, v44
  v_mul_f32 v45, 0x3fb8aa3b, v45
  v_mul_f32 v46, 0x3fb8aa3b, v46
  v_mul_f32 v47, 0x3fb8aa3b, v47
  v_mul_f32 v48, 0x3fb8aa3b, v48
  v_mul_f32 v49, 0x3fb8aa3b, v49
  v_mul_f32 v50, 0x3fb8aa3b, v50
  v_mul_f32 v51, 0x3fb8aa3b, v51
  v_mul_f32 v52, 0x3fb8aa3b, v52
  v_mul_f32 v53, 0x3fb8aa3b, v53
  v_mul_f32 v54, 0x3fb8aa3b, v54
  v_mul_f32 v55, 0x3fb8aa3b, v55
  v_exp_f32 v42, v42
  v_exp_f32 v43, v43
  v_exp_f32 v44, v44
  v_exp_f32 v45, v45
  v_exp_f32 v46, v46
  v_exp_f32 v47, v47
  v_exp_f32 v48, v48
  v_exp_f32 v49, v49
  v_exp_f32 v50, v50
  v_exp_f32 v51, v51
  v_exp_f32 v52, v52
  v_exp_f32 v53, v53
  v_exp_f32 v54, v54
  v_exp_f32 v55, v55
  s_waitcnt vmcnt(60)
  v_dot2c_f32_bf16 v72, v112, v30
  v_dot2c_f32_bf16 v72, v113, v31
  v_dot2c_f32_bf16 v72, v114, v32
  v_dot2c_f32_bf16 v72, v115, v33
  v_dot2c_f32_bf16 v72, v116, v34
  v_dot2c_f32_bf16 v72, v117, v35
  v_dot2c_f32_bf16 v72, v118, v36
  v_dot2c_f32_bf16 v72, v119, v37
  v_dot2c_f32_bf16 v72, v120, v38
  v_dot2c_f32_bf16 v72, v121, v39
  v_dot2c_f32_bf16 v72, v122, v40
  v_dot2c_f32_bf16 v72, v123, v41
  s_add_u32 s80, s15, 15
  s_and_b32 s80, s80, 31
  s_mul_i32 s80, s80, 49152
  buffer_load_dwordx4 v[112:115], v2, s[32:35], s80 offen offset:0 nt
  buffer_load_dwordx4 v[116:119], v2, s[32:35], s80 offen offset:128 nt
  buffer_load_dwordx4 v[120:123], v2, s[32:35], s80 offen offset:256 nt
  s_mov_b32 s80, 46080
  buffer_load_dwordx4 a[180:183], v4, s[40:43], s80 offen offset:512
  s_mov_b32 s80, 40960
  buffer_load_dwordx4 a[184:187], v4, s[40:43], s80 offen offset:768
  s_mov_b32 s80, 46080
  buffer_load_dwordx4 a[188:191], v4, s[40:43], s80 offen offset:768
  v_sub_f32 v56, v56, v83
  v_sub_f32 v57, v57, v83
  v_sub_f32 v58, v58, v83
  v_sub_f32 v59, v59, v83
  v_sub_f32 v60, v60, v83
  v_sub_f32 v61, v61, v83
  v_sub_f32 v62, v62, v83
  v_sub_f32 v63, v63, v83
  v_sub_f32 v64, v64, v83
  v_sub_f32 v65, v65, v83
  v_sub_f32 v66, v66, v83
  v_sub_f32 v67, v67, v83
  v_sub_f32 v68, v68, v83
  v_sub_f32 v69, v69, v83
  v_mul_f32 v56, 0x3fb8aa3b, v56
  v_mul_f32 v57, 0x3fb8aa3b, v57
  v_mul_f32 v58, 0x3fb8aa3b, v58
  v_mul_f32 v59, 0x3fb8aa3b, v59
  v_mul_f32 v60, 0x3fb8aa3b, v60
  v_mul_f32 v61, 0x3fb8aa3b, v61
  v_mul_f32 v62, 0x3fb8aa3b, v62
  v_mul_f32 v63, 0x3fb8aa3b, v63
  v_mul_f32 v64, 0x3fb8aa3b, v64
  v_mul_f32 v65, 0x3fb8aa3b, v65
  v_mul_f32 v66, 0x3fb8aa3b, v66
  v_mul_f32 v67, 0x3fb8aa3b, v67
  v_mul_f32 v68, 0x3fb8aa3b, v68
  v_mul_f32 v69, 0x3fb8aa3b, v69
  v_exp_f32 v56, v56
  v_exp_f32 v57, v57
  v_exp_f32 v58, v58
  v_exp_f32 v59, v59
  v_exp_f32 v60, v60
  v_exp_f32 v61, v61
  v_exp_f32 v62, v62
  v_exp_f32 v63, v63
  v_exp_f32 v64, v64
  v_exp_f32 v65, v65
  v_exp_f32 v66, v66
  v_exp_f32 v67, v67
  v_exp_f32 v68, v68
  v_exp_f32 v69, v69
  v_add_f32_dpp v70, v70, v70 quad_perm:[1,0,3,2] row_mask:0xf bank_mask:0xf
  v_add_f32_dpp v71, v71, v71 quad_perm:[1,0,3,2] row_mask:0xf bank_mask:0xf
  s_nop 0
  v_add_f32_dpp v70, v70, v70 quad_perm:[2,3,0,1] row_mask:0xf bank_mask:0xf
  v_add_f32_dpp v71, v71, v71 quad_perm:[2,3,0,1] row_mask:0xf bank_mask:0xf
  s_nop 0
  v_add_f32_dpp v70, v70, v70 row_half_mirror row_mask:0xf bank_mask:0xf
  v_add_f32_dpp v71, v71, v71 row_half_mirror row_mask:0xf bank_mask:0xf
  s_nop 0
  v_cvt_pk_bf16_f32 v82, v70, v71
  v_lshlrev_b32 v70, 16, v82
  v_and_b32 v71, 0xffff0000, v82
  v_mul_f32 v70, 0x3d93cd3a, v70
  v_mul_f32 v71, 0x3d93cd3a, v71
  v_cvt_pk_bf16_f32 v82, v70, v71
  v_lshlrev_b32 v70, 16, v82
  v_and_b32 v71, 0xffff0000, v82
  v_max3_f32 v74, v74, v70, v71
  v_add_f32 v84, v42, v43
  v_add_f32 v82, v44, v45
  v_add_f32 v84, v84, v46
  v_add_f32 v82, v82, v47
  v_add_f32 v84, v84, v48
  v_add_f32 v82, v82, v49
  v_add_f32 v84, v84, v50
  v_add_f32 v82, v82, v51
  v_add_f32 v84, v84, v52
  v_add_f32 v82, v82, v53
  v_add_f32 v84, v84, v54
  v_add_f32 v82, v82, v55
  v_add_f32 v84, v84, v56
  v_add_f32 v82, v82, v57
  v_add_f32 v84, v84, v58
  v_add_f32 v82, v82, v59
  v_add_f32 v84, v84, v60
  v_add_f32 v82, v82, v61
  v_add_f32 v84, v84, v62
  v_add_f32 v82, v82, v63
  v_add_f32 v84, v84, v64
  v_add_f32 v82, v82, v65
  v_add_f32 v84, v84, v66
  v_add_f32 v82, v82, v67
  v_add_f32 v84, v84, v68
  v_add_f32 v82, v82, v69
  v_add_f32 v84, v84, v82
  s_waitcnt vmcnt(60)
  v_dot2c_f32_bf16 v73, v124, v30
  v_dot2c_f32_bf16 v73, v125, v31
  v_dot2c_f32_bf16 v73, v126, v32
  v_dot2c_f32_bf16 v73, v127, v33
  v_dot2c_f32_bf16 v73, v128, v34
  v_dot2c_f32_bf16 v73, v129, v35
  v_dot2c_f32_bf16 v73, v130, v36
  v_dot2c_f32_bf16 v73, v131, v37
  v_dot2c_f32_bf16 v73, v132, v38
  v_dot2c_f32_bf16 v73, v133, v39
  v_dot2c_f32_bf16 v73, v134, v40
  v_dot2c_f32_bf16 v73, v135, v41
  s_add_u32 s80, s15, 16
  s_and_b32 s80, s80, 31
  s_mul_i32 s80, s80, 49152
  buffer_load_dwordx4 v[124:127], v2, s[32:35], s80 offen offset:0 nt
  buffer_load_dwordx4 v[128:131], v2, s[32:35], s80 offen offset:128 nt
  buffer_load_dwordx4 v[132:135], v2, s[32:35], s80 offen offset:256 nt
  v_add_f32_dpp v72, v72, v72 quad_perm:[1,0,3,2] row_mask:0xf bank_mask:0xf
  v_add_f32_dpp v73, v73, v73 quad_perm:[1,0,3,2] row_mask:0xf bank_mask:0xf
  s_nop 0
  v_add_f32_dpp v72, v72, v72 quad_perm:[2,3,0,1] row_mask:0xf bank_mask:0xf
  v_add_f32_dpp v73, v73, v73 quad_perm:[2,3,0,1] row_mask:0xf bank_mask:0xf
  s_nop 0
  v_add_f32_dpp v72, v72, v72 row_half_mirror row_mask:0xf bank_mask:0xf
  v_add_f32_dpp v73, v73, v73 row_half_mirror row_mask:0xf bank_mask:0xf
  s_nop 0
  v_cvt_pk_bf16_f32 v82, v72, v73
  v_lshlrev_b32 v72, 16, v82
  v_and_b32 v73, 0xffff0000, v82
  v_mul_f32 v72, 0x3d93cd3a, v72
  v_mul_f32 v73, 0x3d93cd3a, v73
  v_cvt_pk_bf16_f32 v82, v72, v73
  v_lshlrev_b32 v72, 16, v82
  v_and_b32 v73, 0xffff0000, v82
  v_max3_f32 v74, v74, v72, v73
  s_nop 1
  v_max_f32_dpp v74, v74, v74 row_ror:8 row_mask:0xf bank_mask:0xf
  v_mov_b32 v82, v74
  s_nop 1
  v_permlane16_swap_b32 v74, v82
  s_nop 1
  v_max_f32 v74, v74, v82
  v_mov_b32 v82, v74
  s_nop 1
  v_permlane32_swap_b32 v74, v82
  s_nop 1
  v_max_f32 v74, v74, v82
  v_sub_f32 v41, v83, v74
  v_mul_f32 v41, 0x3fb8aa3b, v41
  v_exp_f32 v41, v41
  v_sub_f32 v70, v70, v74
  v_sub_f32 v71, v71, v74
  v_sub_f32 v72, v72, v74
  v_sub_f32 v73, v73, v74
  v_mul_f32 v70, 0x3fb8aa3b, v70
  v_mul_f32 v71, 0x3fb8aa3b, v71
  v_mul_f32 v72, 0x3fb8aa3b, v72
  v_mul_f32 v73, 0x3fb8aa3b, v73
  v_exp_f32 v70, v70
  v_exp_f32 v71, v71
  v_exp_f32 v72, v72
  v_exp_f32 v73, v73
  v_mul_f32 v45, v45, v41
  v_cvt_pk_bf16_f32 v45, v45, v45
  v_and_b32 v10, v45, v6
  v_and_b32 v11, v45, v7
  v_and_b32 v12, v45, v8
  v_and_b32 v13, v45, v9
  s_nop 0
  s_waitcnt vmcnt(60)
  v_mfma_f32_16x16x32_bf16 v[18:21], v[10:13], v[136:139], 0
  v_mfma_f32_16x16x32_bf16 v[22:25], v[10:13], v[140:143], 0
  v_mfma_f32_16x16x32_bf16 v[26:29], v[10:13], v[144:147], 0
  s_add_u32 s80, s15, 17
  s_and_b32 s80, s80, 31
  s_mul_i32 s80, s80, 49152
  buffer_load_dwordx4 v[136:139], v2, s[32:35], s80 offen offset:0 nt
  buffer_load_dwordx4 v[140:143], v2, s[32:35], s80 offen offset:128 nt
  buffer_load_dwordx4 v[144:147], v2, s[32:35], s80 offen offset:256 nt
  s_mov_b32 s80, 40960
  buffer_load_dwordx4 a[192:195], v4, s[40:43], s80 offen offset:1024
  s_mov_b32 s80, 46080
  buffer_load_dwordx4 a[196:199], v4, s[40:43], s80 offen offset:1024
  s_mov_b32 s80, 51200
  buffer_load_dwordx4 a[200:203], v4, s[40:43], s80 offen offset:0
  v_mul_f32 v75, v84, v41
  v_add_f32 v75, v75, v70
  v_add_f32 v75, v75, v71
  v_add_f32 v75, v75, v72
  v_add_f32 v75, v75, v73
  s_nop 1
  v_add_f32_dpp v75, v75, v75 row_ror:8 row_mask:0xf bank_mask:0xf
  v_mov_b32 v82, v75
  s_nop 1
  v_permlane16_swap_b32 v75, v82
  s_nop 1
  v_add_f32 v75, v75, v82
  v_mov_b32 v82, v75
  s_nop 1
  v_permlane32_swap_b32 v75, v82
  s_nop 1
  v_add_f32 v75, v75, v82
  s_lshl_b32 s81, s72, 3
  s_add_u32 s81, s81, 36864
  v_mov_b32 v82, s81
  ds_write_b64 v82, v[74:75]
  v_mul_f32 v42, v42, v41
  v_cvt_pk_bf16_f32 v42, v42, v42
  v_and_b32 v14, v42, v6
  v_and_b32 v15, v42, v7
  v_and_b32 v16, v42, v8
  v_and_b32 v17, v42, v9
  s_nop 0
  s_waitcnt vmcnt(63)
  v_mfma_f32_16x16x32_bf16 v[18:21], v[14:17], a[204:207], v[18:21]
  v_mfma_f32_16x16x32_bf16 v[22:25], v[14:17], a[208:211], v[22:25]
  v_mfma_f32_16x16x32_bf16 v[26:29], v[14:17], a[212:215], v[26:29]
  v_mul_f32 v46, v46, v41
  v_cvt_pk_bf16_f32 v46, v46, v46
  v_and_b32 v10, v46, v6
  v_and_b32 v11, v46, v7
  v_and_b32 v12, v46, v8
  v_and_b32 v13, v46, v9
  s_nop 0
  s_waitcnt vmcnt(60)
  v_mfma_f32_16x16x32_bf16 v[18:21], v[10:13], v[148:151], v[18:21]
  v_mfma_f32_16x16x32_bf16 v[22:25], v[10:13], v[152:155], v[22:25]
  v_mfma_f32_16x16x32_bf16 v[26:29], v[10:13], v[156:159], v[26:29]
  s_add_u32 s80, s15, 18
  s_and_b32 s80, s80, 31
  s_mul_i32 s80, s80, 49152
  buffer_load_dwordx4 v[148:151], v2, s[32:35], s80 offen offset:0 nt
  buffer_load_dwordx4 v[152:155], v2, s[32:35], s80 offen offset:128 nt
  buffer_load_dwordx4 v[156:159], v2, s[32:35], s80 offen offset:256 nt
  v_mul_f32 v43, v43, v41
  v_cvt_pk_bf16_f32 v43, v43, v43
  v_and_b32 v14, v43, v6
  v_and_b32 v15, v43, v7
  v_and_b32 v16, v43, v8
  v_and_b32 v17, v43, v9
  s_nop 0
  s_waitcnt vmcnt(63)
  v_mfma_f32_16x16x32_bf16 v[18:21], v[14:17], a[216:219], v[18:21]
  v_mfma_f32_16x16x32_bf16 v[22:25], v[14:17], a[220:223], v[22:25]
  v_mfma_f32_16x16x32_bf16 v[26:29], v[14:17], a[224:227], v[26:29]
  v_mul_f32 v47, v47, v41
  v_cvt_pk_bf16_f32 v47, v47, v47
  v_and_b32 v10, v47, v6
  v_and_b32 v11, v47, v7
  v_and_b32 v12, v47, v8
  v_and_b32 v13, v47, v9
  s_nop 0
  s_waitcnt vmcnt(60)
  v_mfma_f32_16x16x32_bf16 v[18:21], v[10:13], v[160:163], v[18:21]
  v_mfma_f32_16x16x32_bf16 v[22:25], v[10:13], v[164:167], v[22:25]
  v_mfma_f32_16x16x32_bf16 v[26:29], v[10:13], v[168:171], v[26:29]
  s_add_u32 s80, s15, 19
  s_and_b32 s80, s80, 31
  s_mul_i32 s80, s80, 49152
  buffer_load_dwordx4 v[160:163], v2, s[32:35], s80 offen offset:0 nt
  buffer_load_dwordx4 v[164:167], v2, s[32:35], s80 offen offset:128 nt
  buffer_load_dwordx4 v[168:171], v2, s[32:35], s80 offen offset:256 nt
  s_mov_b32 s80, 56320
  buffer_load_dwordx4 a[204:207], v4, s[40:43], s80 offen offset:0
  s_mov_b32 s80, 51200
  buffer_load_dwordx4 a[208:211], v4, s[40:43], s80 offen offset:256
  s_mov_b32 s80, 56320
  buffer_load_dwordx4 a[212:215], v4, s[40:43], s80 offen offset:256
  v_mul_f32 v44, v44, v41
  v_cvt_pk_bf16_f32 v44, v44, v44
  v_and_b32 v14, v44, v6
  v_and_b32 v15, v44, v7
  v_and_b32 v16, v44, v8
  v_and_b32 v17, v44, v9
  s_nop 0
  s_waitcnt vmcnt(63)
  v_mfma_f32_16x16x32_bf16 v[18:21], v[14:17], a[228:231], v[18:21]
  v_mfma_f32_16x16x32_bf16 v[22:25], v[14:17], a[232:235], v[22:25]
  v_mfma_f32_16x16x32_bf16 v[26:29], v[14:17], a[236:239], v[26:29]
  v_bfe_u32 v82, v1, 1, 2
  v_lshlrev_b32 v82, 3, v82
  s_waitcnt lgkmcnt(0)
  s_barrier
  ds_read_b64 v[30:31], v82 offset:36864
  s_waitcnt lgkmcnt(0)
  v_mov_b32 v32, v30
  s_nop 1
  v_max_f32_dpp v32, v32, v32 quad_perm:[2,3,0,1] row_mask:0xf bank_mask:0xf
  s_nop 1
  v_max_f32_dpp v32, v32, v32 row_half_mirror row_mask:0xf bank_mask:0xf
  v_sub_f32 v33, v30, v32
  v_mul_f32 v33, 0x3fb8aa3b, v33
  v_exp_f32 v33, v33
  s_nop 0
  v_mul_f32 v30, v33, v31
  s_nop 1
  v_add_f32_dpp v30, v30, v30 quad_perm:[2,3,0,1] row_mask:0xf bank_mask:0xf
  s_nop 1
  v_add_f32_dpp v30, v30, v30 row_half_mirror row_mask:0xf bank_mask:0xf
  v_rcp_f32 v31, v30
  v_add_u32 v34, 0x80, v32
  v_perm_b32 v34, v76, v34, s16
  v_add_u32 v35, 0x80, v30
  v_perm_b32 v35, v76, v35, s17
  v_add_u32 v36, 0x80, v32
  v_perm_b32 v36, v76, v36, s18
  v_add_u32 v37, 0x80, v30
  v_perm_b32 v37, v76, v37, s19
  v_mul_f32 v39, v33, v31
  s_lshl_b32 s81, s73, 7
  s_add_u32 s81, s81, s75
  s_lshl_b32 s81, s81, 7
  s_add_u32 s91, s81, 1220608
  v_mov_b32 v74, v32
  v_mov_b32 v75, v30
  v_lshlrev_b32 v81, 4, v1
  s_cmp_lg_u32 s72, 3
  s_cbranch_scc1 L_noml_6
  s_mov_b64 exec, 0xff
  buffer_store_dwordx4 v[34:37], v81, s[60:63], s91 offen sc1
  s_mov_b64 exec, -1
L_noml_6:
  s_and_b32 s91, s91, 4294966784
  v_and_b32 v81, 3, v1
  v_lshlrev_b32 v81, 7, v81
  v_bfe_u32 v82, v1, 2, 3
  v_lshl_add_u32 v81, v82, 4, v81
  v_mul_f32 v48, v48, v41
  v_cvt_pk_bf16_f32 v48, v48, v48
  v_and_b32 v10, v48, v6
  v_and_b32 v11, v48, v7
  v_and_b32 v12, v48, v8
  v_and_b32 v13, v48, v9
  s_nop 0
  s_waitcnt vmcnt(60)
  v_mfma_f32_16x16x32_bf16 v[18:21], v[10:13], v[172:175], v[18:21]
  v_mfma_f32_16x16x32_bf16 v[22:25], v[10:13], v[176:179], v[22:25]
  v_mfma_f32_16x16x32_bf16 v[26:29], v[10:13], v[180:183], v[26:29]
  s_add_u32 s80, s15, 20
  s_and_b32 s80, s80, 31
  s_mul_i32 s80, s80, 49152
  buffer_load_dwordx4 v[172:175], v2, s[32:35], s80 offen offset:0 nt
  buffer_load_dwordx4 v[176:179], v2, s[32:35], s80 offen offset:128 nt
  buffer_load_dwordx4 v[180:183], v2, s[32:35], s80 offen offset:256 nt
  v_mul_f32 v49, v49, v41
  v_cvt_pk_bf16_f32 v49, v49, v49
  v_and_b32 v14, v49, v6
  v_and_b32 v15, v49, v7
  v_and_b32 v16, v49, v8
  v_and_b32 v17, v49, v9
  s_nop 0
  s_waitcnt vmcnt(60)
  v_mfma_f32_16x16x32_bf16 v[18:21], v[14:17], v[184:187], v[18:21]
  v_mfma_f32_16x16x32_bf16 v[22:25], v[14:17], v[188:191], v[22:25]
  v_mfma_f32_16x16x32_bf16 v[26:29], v[14:17], v[192:195], v[26:29]
  s_add_u32 s80, s15, 21
  s_and_b32 s80, s80, 31
  s_mul_i32 s80, s80, 49152
  buffer_load_dwordx4 v[184:187], v2, s[32:35], s80 offen offset:0 nt
  buffer_load_dwordx4 v[188:191], v2, s[32:35], s80 offen offset:128 nt
  buffer_load_dwordx4 v[192:195], v2, s[32:35], s80 offen offset:256 nt
  v_mul_f32 v50, v50, v41
  v_cvt_pk_bf16_f32 v50, v50, v50
  v_and_b32 v10, v50, v6
  v_and_b32 v11, v50, v7
  v_and_b32 v12, v50, v8
  v_and_b32 v13, v50, v9
  s_nop 0
  s_waitcnt vmcnt(57)
  v_mfma_f32_16x16x32_bf16 v[18:21], v[10:13], v[196:199], v[18:21]
  v_mfma_f32_16x16x32_bf16 v[22:25], v[10:13], v[200:203], v[22:25]
  v_mfma_f32_16x16x32_bf16 v[26:29], v[10:13], v[204:207], v[26:29]
  s_add_u32 s80, s15, 22
  s_and_b32 s80, s80, 31
  s_mul_i32 s80, s80, 49152
  buffer_load_dwordx4 v[196:199], v2, s[32:35], s80 offen offset:0 nt
  buffer_load_dwordx4 v[200:203], v2, s[32:35], s80 offen offset:128 nt
  buffer_load_dwordx4 v[204:207], v2, s[32:35], s80 offen offset:256 nt
  s_mov_b32 s80, 51200
  buffer_load_dwordx4 a[216:219], v4, s[40:43], s80 offen offset:512
  s_mov_b32 s80, 56320
  buffer_load_dwordx4 a[220:223], v4, s[40:43], s80 offen offset:512
  s_mov_b32 s80, 51200
  buffer_load_dwordx4 a[224:227], v4, s[40:43], s80 offen offset:768
  v_mul_f32 v51, v51, v41
  v_cvt_pk_bf16_f32 v51, v51, v51
  v_and_b32 v14, v51, v6
  v_and_b32 v15, v51, v7
  v_and_b32 v16, v51, v8
  v_and_b32 v17, v51, v9
  s_nop 0
  s_waitcnt vmcnt(60)
  v_mfma_f32_16x16x32_bf16 v[18:21], v[14:17], v[208:211], v[18:21]
  v_mfma_f32_16x16x32_bf16 v[22:25], v[14:17], v[212:215], v[22:25]
  v_mfma_f32_16x16x32_bf16 v[26:29], v[14:17], v[216:219], v[26:29]
  s_add_u32 s80, s15, 23
  s_and_b32 s80, s80, 31
  s_mul_i32 s80, s80, 49152
  buffer_load_dwordx4 v[208:211], v2, s[32:35], s80 offen offset:0 nt
  buffer_load_dwordx4 v[212:215], v2, s[32:35], s80 offen offset:128 nt
  buffer_load_dwordx4 v[216:219], v2, s[32:35], s80 offen offset:256 nt
  v_mul_f32 v52, v52, v41
  v_cvt_pk_bf16_f32 v52, v52, v52
  v_and_b32 v10, v52, v6
  v_and_b32 v11, v52, v7
  v_and_b32 v12, v52, v8
  v_and_b32 v13, v52, v9
  s_nop 0
  s_waitcnt vmcnt(57)
  v_mfma_f32_16x16x32_bf16 v[18:21], v[10:13], v[220:223], v[18:21]
  v_mfma_f32_16x16x32_bf16 v[22:25], v[10:13], v[224:227], v[22:25]
  v_mfma_f32_16x16x32_bf16 v[26:29], v[10:13], v[228:231], v[26:29]
  s_add_u32 s80, s15, 24
  s_and_b32 s80, s80, 31
  s_mul_i32 s80, s80, 49152
  buffer_load_dwordx4 v[220:223], v2, s[32:35], s80 offen offset:0 nt
  buffer_load_dwordx4 v[224:227], v2, s[32:35], s80 offen offset:128 nt
  buffer_load_dwordx4 v[228:231], v2, s[32:35], s80 offen offset:256 nt
  v_mul_f32 v53, v53, v41
  v_cvt_pk_bf16_f32 v53, v53, v53
  v_and_b32 v14, v53, v6
  v_and_b32 v15, v53, v7
  v_and_b32 v16, v53, v8
  v_and_b32 v17, v53, v9
  s_nop 0
  s_waitcnt vmcnt(57)
  v_mfma_f32_16x16x32_bf16 v[18:21], v[14:17], v[232:235], v[18:21]
  v_mfma_f32_16x16x32_bf16 v[22:25], v[14:17], v[236:239], v[22:25]
  v_mfma_f32_16x16x32_bf16 v[26:29], v[14:17], v[240:243], v[26:29]
  s_add_u32 s80, s15, 25
  s_and_b32 s80, s80, 31
  s_mul_i32 s80, s80, 49152
  buffer_load_dwordx4 v[232:235], v2, s[32:35], s80 offen offset:0 nt
  buffer_load_dwordx4 v[236:239], v2, s[32:35], s80 offen offset:128 nt
  buffer_load_dwordx4 v[240:243], v2, s[32:35], s80 offen offset:256 nt
  v_mul_f32 v54, v54, v41
  v_cvt_pk_bf16_f32 v54, v54, v54
  v_and_b32 v10, v54, v6
  v_and_b32 v11, v54, v7
  v_and_b32 v12, v54, v8
  v_and_b32 v13, v54, v9
  s_nop 0
  s_waitcnt vmcnt(54)
  v_mfma_f32_16x16x32_bf16 v[18:21], v[10:13], v[244:247], v[18:21]
  v_mfma_f32_16x16x32_bf16 v[22:25], v[10:13], v[248:251], v[22:25]
  v_mfma_f32_16x16x32_bf16 v[26:29], v[10:13], v[252:255], v[26:29]
  buffer_load_dwordx4 v[30:33], v81, s[60:63], s91 offen sc1
  s_lshr_b32 s81, s2, 6
  s_lshl_b32 s81, s81, 1
  s_sub_u32 s82, s69, 4
  s_add_u32 s81, s81, s82
  s_cmp_lt_u32 s82, 2
  s_cselect_b32 s81, s81, 99
  s_and_b32 s82, s2, 7
  s_mul_i32 s89, s82, 5
  s_add_u32 s89, s89, s81
  s_cmp_lt_u32 s81, 5
  s_cselect_b32 s52, 1, 0
  s_cselect_b32 s94, 1257472, 0
  s_cmp_ge_u32 s89, 20
  s_cselect_b32 s73, 1, 0
  s_mul_i32 s81, s73, 20
  s_sub_u32 s74, s89, s81
  v_lshlrev_b32 v53, 4, v1
  s_lshl_b32 s81, s89, 14
  s_lshl_b32 s82, s72, 12
  s_add_u32 s81, s81, s82
  s_add_u32 s81, s81, 565248
  v_add_u32 v42, s81, v53
  s_lshr_b32 s81, s74, 2
  s_lshl_b32 s81, s81, 1
  s_add_u32 s81, s81, s73
  s_lshl_b32 s81, s81, 2
  s_and_b32 s82, s74, 3
  s_add_u32 s81, s81, s82
  s_mul_i32 s81, s81, 3072
  s_mul_i32 s82, s72, 768
  s_add_u32 s81, s81, s82
  s_add_u32 s81, s81, 442368
  v_min_u32 v53, 752, v53
  v_add_u32 v53, s81, v53
  v_lshrrev_b32 v43, 3, v1
  v_lshlrev_b32 v43, 7, v43
  s_lshl_b32 s81, s73, 14
  s_lshl_b32 s82, s72, 12
  s_add_u32 s81, s81, s82
  s_add_u32 s81, s81, 1220608
  v_add_u32 v43, s81, v43
  v_and_b32 v51, 31, v1
  v_lshlrev_b32 v49, 1, v51
  s_lshl_b32 s81, s89, 6
  v_add_u32 v49, s81, v49
  v_lshlrev_b32 v51, 2, v51
  v_add_u32 v51, 53760, v51
  buffer_load_dwordx4 v[44:47], v53, s[92:95], 0 offen sc1
  buffer_load_ushort v48, v49, s[44:47], 0 offen
  v_and_b32 v50, 7, v1
  v_lshlrev_b32 v50, 4, v50
  v_bfe_u32 v52, v1, 4, 1
  v_lshl_add_u32 v50, v52, 3, v50
  v_lshrrev_b32 v52, 5, v1
  v_lshl_add_u32 v50, v52, 2, v50
  s_lshl_b32 s81, s72, 7
  v_add_u32 v50, s81, v50
  s_add_u32 s80, s15, 26
  s_and_b32 s80, s80, 31
  s_mul_i32 s80, s80, 49152
  buffer_load_dwordx4 v[244:247], v2, s[32:35], s80 offen offset:0 nt
  buffer_load_dwordx4 v[248:251], v2, s[32:35], s80 offen offset:128 nt
  buffer_load_dwordx4 v[252:255], v2, s[32:35], s80 offen offset:256 nt
  s_mov_b32 s80, 56320
  buffer_load_dwordx4 a[228:231], v4, s[40:43], s80 offen offset:768
  s_mov_b32 s80, 51200
  buffer_load_dwordx4 a[232:235], v4, s[40:43], s80 offen offset:1024
  s_mov_b32 s80, 56320
  buffer_load_dwordx4 a[236:239], v4, s[40:43], s80 offen offset:1024
  v_mul_f32 v55, v55, v41
  v_cvt_pk_bf16_f32 v55, v55, v55
  v_and_b32 v14, v55, v6
  v_and_b32 v15, v55, v7
  v_and_b32 v16, v55, v8
  v_and_b32 v17, v55, v9
  s_nop 0
  s_waitcnt vmcnt(60)
  v_mfma_f32_16x16x32_bf16 v[18:21], v[14:17], v[88:91], v[18:21]
  v_mfma_f32_16x16x32_bf16 v[22:25], v[14:17], v[92:95], v[22:25]
  v_mfma_f32_16x16x32_bf16 v[26:29], v[14:17], v[96:99], v[26:29]
  s_add_u32 s80, s15, 27
  s_and_b32 s80, s80, 31
  s_mul_i32 s80, s80, 49152
  buffer_load_dwordx4 v[88:91], v2, s[32:35], s80 offen offset:0 nt
  buffer_load_dwordx4 v[92:95], v2, s[32:35], s80 offen offset:128 nt
  buffer_load_dwordx4 v[96:99], v2, s[32:35], s80 offen offset:256 nt
  v_mul_f32 v56, v56, v41
  v_cvt_pk_bf16_f32 v56, v56, v56
  v_and_b32 v10, v56, v6
  v_and_b32 v11, v56, v7
  v_and_b32 v12, v56, v8
  v_and_b32 v13, v56, v9
  s_nop 0
  s_waitcnt vmcnt(57)
  v_mfma_f32_16x16x32_bf16 v[18:21], v[10:13], v[100:103], v[18:21]
  v_mfma_f32_16x16x32_bf16 v[22:25], v[10:13], v[104:107], v[22:25]
  v_mfma_f32_16x16x32_bf16 v[26:29], v[10:13], v[108:111], v[26:29]
  s_add_u32 s80, s15, 28
  s_and_b32 s80, s80, 31
  s_mul_i32 s80, s80, 49152
  buffer_load_dwordx4 v[100:103], v2, s[32:35], s80 offen offset:0 nt
  buffer_load_dwordx4 v[104:107], v2, s[32:35], s80 offen offset:128 nt
  buffer_load_dwordx4 v[108:111], v2, s[32:35], s80 offen offset:256 nt
  v_mul_f32 v57, v57, v41
  v_cvt_pk_bf16_f32 v57, v57, v57
  v_and_b32 v14, v57, v6
  v_and_b32 v15, v57, v7
  v_and_b32 v16, v57, v8
  v_and_b32 v17, v57, v9
  s_nop 0
  s_waitcnt vmcnt(57)
  v_mfma_f32_16x16x32_bf16 v[18:21], v[14:17], v[112:115], v[18:21]
  v_mfma_f32_16x16x32_bf16 v[22:25], v[14:17], v[116:119], v[22:25]
  v_mfma_f32_16x16x32_bf16 v[26:29], v[14:17], v[120:123], v[26:29]
  s_add_u32 s80, s15, 29
  s_and_b32 s80, s80, 31
  s_mul_i32 s80, s80, 49152
  buffer_load_dwordx4 v[112:115], v2, s[32:35], s80 offen offset:0 nt
  buffer_load_dwordx4 v[116:119], v2, s[32:35], s80 offen offset:128 nt
  buffer_load_dwordx4 v[120:123], v2, s[32:35], s80 offen offset:256 nt
  v_mul_f32 v58, v58, v41
  v_cvt_pk_bf16_f32 v58, v58, v58
  v_and_b32 v10, v58, v6
  v_and_b32 v11, v58, v7
  v_and_b32 v12, v58, v8
  v_and_b32 v13, v58, v9
  s_nop 0
  s_waitcnt vmcnt(54)
  v_mfma_f32_16x16x32_bf16 v[18:21], v[10:13], v[124:127], v[18:21]
  v_mfma_f32_16x16x32_bf16 v[22:25], v[10:13], v[128:131], v[22:25]
  v_mfma_f32_16x16x32_bf16 v[26:29], v[10:13], v[132:135], v[26:29]
  s_add_u32 s80, s15, 30
  s_and_b32 s80, s80, 31
  s_mul_i32 s80, s80, 49152
  buffer_load_dwordx4 v[124:127], v2, s[32:35], s80 offen offset:0 nt
  buffer_load_dwordx4 v[128:131], v2, s[32:35], s80 offen offset:128 nt
  buffer_load_dwordx4 v[132:135], v2, s[32:35], s80 offen offset:256 nt
  v_mul_f32 v59, v59, v41
  v_cvt_pk_bf16_f32 v59, v59, v59
  v_and_b32 v14, v59, v6
  v_and_b32 v15, v59, v7
  v_and_b32 v16, v59, v8
  v_and_b32 v17, v59, v9
  s_nop 0
  s_waitcnt vmcnt(54)
  v_mfma_f32_16x16x32_bf16 v[18:21], v[14:17], v[136:139], v[18:21]
  v_mfma_f32_16x16x32_bf16 v[22:25], v[14:17], v[140:143], v[22:25]
  v_mfma_f32_16x16x32_bf16 v[26:29], v[14:17], v[144:147], v[26:29]
  s_add_u32 s80, s15, 31
  s_and_b32 s80, s80, 31
  s_mul_i32 s80, s80, 49152
  buffer_load_dwordx4 v[136:139], v2, s[32:35], s80 offen offset:0 nt
  buffer_load_dwordx4 v[140:143], v2, s[32:35], s80 offen offset:128 nt
  buffer_load_dwordx4 v[144:147], v2, s[32:35], s80 offen offset:256 nt
  v_mul_f32 v60, v60, v41
  v_cvt_pk_bf16_f32 v60, v60, v60
  v_and_b32 v10, v60, v6
  v_and_b32 v11, v60, v7
  v_and_b32 v12, v60, v8
  v_and_b32 v13, v60, v9
  s_nop 0
  s_waitcnt vmcnt(51)
  v_mfma_f32_16x16x32_bf16 v[18:21], v[10:13], v[148:151], v[18:21]
  v_mfma_f32_16x16x32_bf16 v[22:25], v[10:13], v[152:155], v[22:25]
  v_mfma_f32_16x16x32_bf16 v[26:29], v[10:13], v[156:159], v[26:29]
  v_mul_f32 v61, v61, v41
  v_cvt_pk_bf16_f32 v61, v61, v61
  v_and_b32 v14, v61, v6
  v_and_b32 v15, v61, v7
  v_and_b32 v16, v61, v8
  v_and_b32 v17, v61, v9
  s_nop 0
  s_waitcnt vmcnt(48)
  v_mfma_f32_16x16x32_bf16 v[18:21], v[14:17], v[160:163], v[18:21]
  v_mfma_f32_16x16x32_bf16 v[22:25], v[14:17], v[164:167], v[22:25]
  v_mfma_f32_16x16x32_bf16 v[26:29], v[14:17], v[168:171], v[26:29]
  v_mul_f32 v62, v62, v41
  v_cvt_pk_bf16_f32 v62, v62, v62
  v_and_b32 v10, v62, v6
  v_and_b32 v11, v62, v7
  v_and_b32 v12, v62, v8
  v_and_b32 v13, v62, v9
  s_nop 0
  s_waitcnt vmcnt(42)
  v_mfma_f32_16x16x32_bf16 v[18:21], v[10:13], v[172:175], v[18:21]
  v_mfma_f32_16x16x32_bf16 v[22:25], v[10:13], v[176:179], v[22:25]
  v_mfma_f32_16x16x32_bf16 v[26:29], v[10:13], v[180:183], v[26:29]
  v_mul_f32 v63, v63, v41
  v_cvt_pk_bf16_f32 v63, v63, v63
  v_and_b32 v14, v63, v6
  v_and_b32 v15, v63, v7
  v_and_b32 v16, v63, v8
  v_and_b32 v17, v63, v9
  s_nop 0
  s_waitcnt vmcnt(39)
  v_mfma_f32_16x16x32_bf16 v[18:21], v[14:17], v[184:187], v[18:21]
  v_mfma_f32_16x16x32_bf16 v[22:25], v[14:17], v[188:191], v[22:25]
  v_mfma_f32_16x16x32_bf16 v[26:29], v[14:17], v[192:195], v[26:29]
  v_mul_f32 v64, v64, v41
  v_cvt_pk_bf16_f32 v64, v64, v64
  v_and_b32 v10, v64, v6
  v_and_b32 v11, v64, v7
  v_and_b32 v12, v64, v8
  v_and_b32 v13, v64, v9
  s_nop 0
  s_waitcnt vmcnt(36)
  v_mfma_f32_16x16x32_bf16 v[18:21], v[10:13], v[196:199], v[18:21]
  v_mfma_f32_16x16x32_bf16 v[22:25], v[10:13], v[200:203], v[22:25]
  v_mfma_f32_16x16x32_bf16 v[26:29], v[10:13], v[204:207], v[26:29]
  v_mul_f32 v65, v65, v41
  v_cvt_pk_bf16_f32 v65, v65, v65
  v_and_b32 v14, v65, v6
  v_and_b32 v15, v65, v7
  v_and_b32 v16, v65, v8
  v_and_b32 v17, v65, v9
  s_nop 0
  s_waitcnt vmcnt(30)
  v_mfma_f32_16x16x32_bf16 v[18:21], v[14:17], v[208:211], v[18:21]
  v_mfma_f32_16x16x32_bf16 v[22:25], v[14:17], v[212:215], v[22:25]
  v_mfma_f32_16x16x32_bf16 v[26:29], v[14:17], v[216:219], v[26:29]
  v_mul_f32 v66, v66, v41
  v_cvt_pk_bf16_f32 v66, v66, v66
  v_and_b32 v10, v66, v6
  v_and_b32 v11, v66, v7
  v_and_b32 v12, v66, v8
  v_and_b32 v13, v66, v9
  s_nop 0
  s_waitcnt vmcnt(27)
  v_mfma_f32_16x16x32_bf16 v[18:21], v[10:13], v[220:223], v[18:21]
  v_mfma_f32_16x16x32_bf16 v[22:25], v[10:13], v[224:227], v[22:25]
  v_mfma_f32_16x16x32_bf16 v[26:29], v[10:13], v[228:231], v[26:29]
  v_mov_b32 v160, 0
  v_mov_b32 v161, 0
  v_mov_b32 v162, 0
  v_mov_b32 v163, 0
  v_mov_b32 v164, 0
  v_mov_b32 v165, 0
  v_mov_b32 v166, 0
  v_mov_b32 v167, 0
  v_mov_b32 v168, 0
  v_mov_b32 v169, 0
  v_mov_b32 v170, 0
  v_mov_b32 v171, 0
  v_mov_b32 v172, 0
  v_mov_b32 v173, 0
  v_mov_b32 v174, 0
  v_mov_b32 v175, 0
  v_mov_b32 v176, 0
  v_mov_b32 v177, 0
  v_mov_b32 v178, 0
  v_mov_b32 v179, 0
  v_and_b32 v82, 7, v1
  v_mul_u32_u24 v82, 784, v82
  v_lshrrev_b32 v83, 4, v1
  v_lshl_add_u32 v82, v83, 3, v82
  v_bfe_u32 v83, v1, 3, 1
  v_mul_u32_u24 v83, 96, v83
  s_mul_i32 s81, s72, 192
  v_add3_u32 v82, s81, v82, v83
  s_mul_i32 s81, s72, 2560
  v_add_u32 v83, s81, v79
  s_mov_b32 exec_lo, 0
  v_add_u32 v83, 10752, v79
  s_mov_b64 exec, -1
  v_lshlrev_b32 v84, 4, v0
  v_bfe_u32 v86, v1, 2, 1
  v_mul_u32_u24 v86, 0xffff, v86
  v_xor_b32 v85, 0xffff, v86
  v_and_b32 v87, 3, v1
  v_add_u32 v80, 1, v87
  v_and_b32 v80, 3, v80
  v_lshl_or_b32 v87, v80, 2, v87
  v_mul_u32_u24 v87, 0x1111, v87
  v_xor_b32 v200, 0xff, v76
  v_xor_b32 v204, 0xff, v76
  v_xor_b32 v208, 0xff, v76
  v_xor_b32 v212, 0xff, v76
  v_mul_f32 v67, v67, v41
  v_cvt_pk_bf16_f32 v67, v67, v67
  v_and_b32 v14, v67, v6
  v_and_b32 v15, v67, v7
  v_and_b32 v16, v67, v8
  v_and_b32 v17, v67, v9
  s_nop 0
  s_waitcnt vmcnt(24)
  v_mfma_f32_16x16x32_bf16 v[18:21], v[14:17], v[232:235], v[18:21]
  v_mfma_f32_16x16x32_bf16 v[22:25], v[14:17], v[236:239], v[22:25]
  v_mfma_f32_16x16x32_bf16 v[26:29], v[14:17], v[240:243], v[26:29]
  s_waitcnt vmcnt(23)
  s_mov_b32 s88, 65536
L_sibloop_8:
  v_perm_b32 v54, v31, v30, s14
  v_perm_b32 v55, v33, v32, s14
  v_lshl_or_b32 v54, v55, 16, v54
  v_cmp_ne_u32 vcc, v54, v76
  s_nop 4
  s_cbranch_vccz L_sibok_7
  s_sub_u32 s88, s88, 1
  s_cbranch_scc1 L_sibok_7
  s_sleep 4
  buffer_load_dwordx4 v[30:33], v81, s[60:63], s91 offen sc1
  s_waitcnt vmcnt(0)
  s_branch L_sibloop_8
L_sibok_7:
  v_and_b32 v30, 0xffffff00, v30
  v_and_b32 v31, 0xffffff00, v31
  v_mov_b32 v32, v30
  s_nop 1
  v_max_f32_dpp v32, v32, v32 quad_perm:[1,0,3,2] row_mask:0xf bank_mask:0xf
  s_nop 1
  v_max_f32_dpp v32, v32, v32 quad_perm:[2,3,0,1] row_mask:0xf bank_mask:0xf
  v_sub_f32 v30, v30, v32
  v_sub_f32 v33, v74, v32
  v_mul_f32 v30, 0x3fb8aa3b, v30
  v_mul_f32 v33, 0x3fb8aa3b, v33
  v_exp_f32 v30, v30
  v_exp_f32 v33, v33
  v_add_u32 v32, 0x80, v75
  v_and_b32 v32, 0xffffff00, v32
  v_mul_f32 v30, v30, v31
  v_mul_f32 v33, v33, v32
  s_nop 1
  v_add_f32_dpp v30, v30, v30 quad_perm:[1,0,3,2] row_mask:0xf bank_mask:0xf
  s_nop 1
  v_add_f32_dpp v30, v30, v30 quad_perm:[2,3,0,1] row_mask:0xf bank_mask:0xf
  v_rcp_f32 v30, v30
  s_nop 0
  v_mul_f32 v38, v33, v30
  v_mul_f32 v38, v38, v39
  s_lshl_b32 s81, s72, 1
  s_nop 0
  v_readlane_b32 s54, v38, s81
  s_nop 1
  v_mul_f32 v18, s54, v18
  v_mul_f32 v19, s54, v19
  v_mul_f32 v20, s54, v20
  v_mul_f32 v21, s54, v21
  v_mul_f32 v22, s54, v22
  v_mul_f32 v23, s54, v23
  v_mul_f32 v24, s54, v24
  v_mul_f32 v25, s54, v25
  v_mul_f32 v26, s54, v26
  v_mul_f32 v27, s54, v27
  v_mul_f32 v28, s54, v28
  v_mul_f32 v29, s54, v29
  v_mul_f32 v41, s54, v41
  s_cmp_eq_u32 s52, 0
  s_cbranch_scc1 L_nocf_9
  s_waitcnt vmcnt(21)
  s_mov_b32 s88, 65536
L_cfloop_11:
  v_perm_b32 v54, v45, v44, s14
  v_perm_b32 v55, v47, v46, s14
  v_lshl_or_b32 v54, v55, 16, v54
  v_cmp_ne_u32 vcc, v54, v76
  s_nop 4
  s_cbranch_vccz L_cfok_10
  s_sub_u32 s88, s88, 1
  s_cbranch_scc1 L_cfok_10
  s_sleep 4
  buffer_load_dwordx4 v[44:47], v53, s[92:95], 0 offen sc1
  s_waitcnt vmcnt(0)
  s_branch L_cfloop_11
L_cfok_10:
  v_and_b32 v44, 0xffffff00, v44
  v_and_b32 v45, 0xffffff00, v45
  v_and_b32 v46, 0xffffff00, v46
  v_and_b32 v47, 0xffffff00, v47
  s_mov_b32 exec_lo, 0
  s_mov_b32 exec_hi, 0xffff0000
  v_mov_b32 v44, 0
  v_mov_b32 v45, 0
  v_mov_b32 v46, 0
  v_mov_b32 v47, 0
  s_mov_b64 exec, -1
  v_lshlrev_b32 v48, 16, v48
  s_nop 0
  v_permlane32_swap_b32 v44, v45
  v_permlane32_swap_b32 v46, v47
  s_nop 0
  v_add_f32 v44, v44, v45
  v_add_f32 v46, v46, v47
  s_nop 1
  v_permlane16_swap_b32 v44, v46
  s_nop 0
  v_add_f32 v44, v44, v46
  s_nop 1
  v_add_f32_dpp v44, v44, v44 row_ror:8 row_mask:0xf bank_mask:0xf
  ds_write_b32 v50, v44 offset:54272
L_nocf_9:
  v_mul_f32 v68, v68, v41
  v_cvt_pk_bf16_f32 v68, v68, v68
  v_and_b32 v10, v68, v6
  v_and_b32 v11, v68, v7
  v_and_b32 v12, v68, v8
  v_and_b32 v13, v68, v9
  s_nop 0
  s_waitcnt vmcnt(18)
  v_mfma_f32_16x16x32_bf16 v[18:21], v[10:13], v[244:247], v[18:21]
  v_mfma_f32_16x16x32_bf16 v[22:25], v[10:13], v[248:251], v[22:25]
  v_mfma_f32_16x16x32_bf16 v[26:29], v[10:13], v[252:255], v[26:29]
  v_mul_f32 v69, v69, v41
  v_cvt_pk_bf16_f32 v69, v69, v69
  v_and_b32 v14, v69, v6
  v_and_b32 v15, v69, v7
  v_and_b32 v16, v69, v8
  v_and_b32 v17, v69, v9
  s_nop 0
  s_waitcnt vmcnt(12)
  v_mfma_f32_16x16x32_bf16 v[18:21], v[14:17], v[88:91], v[18:21]
  v_mfma_f32_16x16x32_bf16 v[22:25], v[14:17], v[92:95], v[22:25]
  v_mfma_f32_16x16x32_bf16 v[26:29], v[14:17], v[96:99], v[26:29]
  v_mul_f32 v70, s54, v70
  v_cvt_pk_bf16_f32 v70, v70, v70
  v_and_b32 v10, v70, v6
  v_and_b32 v11, v70, v7
  v_and_b32 v12, v70, v8
  v_and_b32 v13, v70, v9
  s_nop 0
  s_waitcnt vmcnt(9)
  v_mfma_f32_16x16x32_bf16 v[18:21], v[10:13], v[100:103], v[18:21]
  v_mfma_f32_16x16x32_bf16 v[22:25], v[10:13], v[104:107], v[22:25]
  v_mfma_f32_16x16x32_bf16 v[26:29], v[10:13], v[108:111], v[26:29]
  v_mul_f32 v71, s54, v71
  v_cvt_pk_bf16_f32 v71, v71, v71
  v_and_b32 v14, v71, v6
  v_and_b32 v15, v71, v7
  v_and_b32 v16, v71, v8
  v_and_b32 v17, v71, v9
  s_nop 0
  s_waitcnt vmcnt(6)
  v_mfma_f32_16x16x32_bf16 v[18:21], v[14:17], v[112:115], v[18:21]
  v_mfma_f32_16x16x32_bf16 v[22:25], v[14:17], v[116:119], v[22:25]
  v_mfma_f32_16x16x32_bf16 v[26:29], v[14:17], v[120:123], v[26:29]
  v_mul_f32 v72, s54, v72
  v_cvt_pk_bf16_f32 v72, v72, v72
  v_and_b32 v10, v72, v6
  v_and_b32 v11, v72, v7
  v_and_b32 v12, v72, v8
  v_and_b32 v13, v72, v9
  s_nop 0
  s_waitcnt vmcnt(3)
  v_mfma_f32_16x16x32_bf16 v[18:21], v[10:13], v[124:127], v[18:21]
  v_mfma_f32_16x16x32_bf16 v[22:25], v[10:13], v[128:131], v[22:25]
  v_mfma_f32_16x16x32_bf16 v[26:29], v[10:13], v[132:135], v[26:29]
  v_mul_f32 v73, s54, v73
  v_cvt_pk_bf16_f32 v73, v73, v73
  v_and_b32 v14, v73, v6
  v_and_b32 v15, v73, v7
  v_and_b32 v16, v73, v8
  v_and_b32 v17, v73, v9
  s_nop 0
  s_waitcnt vmcnt(0)
  v_mfma_f32_16x16x32_bf16 v[18:21], v[14:17], v[136:139], v[18:21]
  v_mfma_f32_16x16x32_bf16 v[22:25], v[14:17], v[140:143], v[22:25]
  v_mfma_f32_16x16x32_bf16 v[26:29], v[14:17], v[144:147], v[26:29]
  s_mov_b64 exec, s[86:87]
  s_nop 4
  ds_write_b128 v78, v[18:21] offset:37120
  ds_write_b128 v78, v[22:25] offset:37376
  ds_write_b128 v78, v[26:29] offset:37632
  s_mov_b64 exec, -1
  s_waitcnt lgkmcnt(0)
  s_barrier
  ds_read_b64 v[58:59], v82 offset:37120
  ds_read_b64 v[60:61], v82 offset:37152
  ds_read_b64 v[62:63], v82 offset:37184
  s_waitcnt lgkmcnt(0)
  v_add_f32_dpp v58, v58, v58 quad_perm:[1,0,3,2] row_mask:0xf bank_mask:0xf
  v_add_f32_dpp v59, v59, v59 quad_perm:[1,0,3,2] row_mask:0xf bank_mask:0xf
  v_add_f32_dpp v60, v60, v60 quad_perm:[1,0,3,2] row_mask:0xf bank_mask:0xf
  v_add_f32_dpp v61, v61, v61 quad_perm:[1,0,3,2] row_mask:0xf bank_mask:0xf
  v_add_f32_dpp v62, v62, v62 quad_perm:[1,0,3,2] row_mask:0xf bank_mask:0xf
  v_add_f32_dpp v63, v63, v63 quad_perm:[1,0,3,2] row_mask:0xf bank_mask:0xf
  v_add_f32_dpp v58, v58, v58 quad_perm:[2,3,0,1] row_mask:0xf bank_mask:0xf
  v_add_f32_dpp v59, v59, v59 quad_perm:[2,3,0,1] row_mask:0xf bank_mask:0xf
  v_add_f32_dpp v60, v60, v60 quad_perm:[2,3,0,1] row_mask:0xf bank_mask:0xf
  v_add_f32_dpp v61, v61, v61 quad_perm:[2,3,0,1] row_mask:0xf bank_mask:0xf
  v_add_f32_dpp v62, v62, v62 quad_perm:[2,3,0,1] row_mask:0xf bank_mask:0xf
  v_add_f32_dpp v63, v63, v63 quad_perm:[2,3,0,1] row_mask:0xf bank_mask:0xf
  v_add_f32_dpp v58, v58, v58 row_half_mirror row_mask:0xf bank_mask:0xf
  v_add_f32_dpp v59, v59, v59 row_half_mirror row_mask:0xf bank_mask:0xf
  v_add_f32_dpp v60, v60, v60 row_half_mirror row_mask:0xf bank_mask:0xf
  v_add_f32_dpp v61, v61, v61 row_half_mirror row_mask:0xf bank_mask:0xf
  v_add_f32_dpp v62, v62, v62 row_half_mirror row_mask:0xf bank_mask:0xf
  v_add_f32_dpp v63, v63, v63 row_half_mirror row_mask:0xf bank_mask:0xf
  v_cvt_pk_bf16_f32 v58, v58, v58
  v_cvt_pk_bf16_f32 v59, v59, v59
  v_cvt_pk_bf16_f32 v60, v60, v60
  v_cvt_pk_bf16_f32 v61, v61, v61
  v_cvt_pk_bf16_f32 v62, v62, v62
  v_cvt_pk_bf16_f32 v63, v63, v63
  v_and_b32 v10, v58, v85
  v_and_b32 v11, v58, v86
  v_and_b32 v12, v59, v85
  v_and_b32 v13, v59, v86
  v_and_b32 v14, v60, v85
  v_and_b32 v15, v60, v86
  v_and_b32 v16, v61, v85
  v_and_b32 v17, v61, v86
  v_smfmac_f32_16x16x64_bf16 v[160:163], v[10:13], a[0:7], v87
  v_and_b32 v18, v62, v85
  v_and_b32 v19, v62, v86
  v_and_b32 v20, v63, v85
  v_and_b32 v21, v63, v86
  v_smfmac_f32_16x16x64_bf16 v[160:163], v[14:17], a[40:47], v87
  v_and_b32_dpp v22, v58, v85 row_ror:8 row_mask:0xf bank_mask:0xf
  v_and_b32_dpp v23, v58, v86 row_ror:8 row_mask:0xf bank_mask:0xf
  v_and_b32_dpp v24, v59, v85 row_ror:8 row_mask:0xf bank_mask:0xf
  v_and_b32_dpp v25, v59, v86 row_ror:8 row_mask:0xf bank_mask:0xf
  v_smfmac_f32_16x16x64_bf16 v[160:163], v[18:21], a[80:87], v87
  v_and_b32_dpp v26, v60, v85 row_ror:8 row_mask:0xf bank_mask:0xf
  v_and_b32_dpp v27, v60, v86 row_ror:8 row_mask:0xf bank_mask:0xf
  v_and_b32_dpp v28, v61, v85 row_ror:8 row_mask:0xf bank_mask:0xf
  v_and_b32_dpp v29, v61, v86 row_ror:8 row_mask:0xf bank_mask:0xf
  v_smfmac_f32_16x16x64_bf16 v[160:163], v[22:25], a[120:127], v87
  v_and_b32_dpp v30, v62, v85 row_ror:8 row_mask:0xf bank_mask:0xf
  v_and_b32_dpp v31, v62, v86 row_ror:8 row_mask:0xf bank_mask:0xf
  v_and_b32_dpp v32, v63, v85 row_ror:8 row_mask:0xf bank_mask:0xf
  v_and_b32_dpp v33, v63, v86 row_ror:8 row_mask:0xf bank_mask:0xf
  v_smfmac_f32_16x16x64_bf16 v[160:163], v[26:29], a[160:167], v87
  s_nop 0
  v_smfmac_f32_16x16x64_bf16 v[160:163], v[30:33], a[200:207], v87
  v_smfmac_f32_16x16x64_bf16 v[164:167], v[10:13], a[8:15], v87
  v_smfmac_f32_16x16x64_bf16 v[164:167], v[14:17], a[48:55], v87
  v_smfmac_f32_16x16x64_bf16 v[164:167], v[18:21], a[88:95], v87
  v_smfmac_f32_16x16x64_bf16 v[164:167], v[22:25], a[128:135], v87
  v_smfmac_f32_16x16x64_bf16 v[164:167], v[26:29], a[168:175], v87
  v_smfmac_f32_16x16x64_bf16 v[164:167], v[30:33], a[208:215], v87
  v_smfmac_f32_16x16x64_bf16 v[168:171], v[10:13], a[16:23], v87
  v_smfmac_f32_16x16x64_bf16 v[168:171], v[14:17], a[56:63], v87
  ds_write_b128 v83, v[160:163] offset:43520
  v_smfmac_f32_16x16x64_bf16 v[168:171], v[18:21], a[96:103], v87
  v_smfmac_f32_16x16x64_bf16 v[168:171], v[22:25], a[136:143], v87
  v_smfmac_f32_16x16x64_bf16 v[168:171], v[26:29], a[176:183], v87
  v_smfmac_f32_16x16x64_bf16 v[168:171], v[30:33], a[216:223], v87
  v_smfmac_f32_16x16x64_bf16 v[172:175], v[10:13], a[24:31], v87
  v_smfmac_f32_16x16x64_bf16 v[172:175], v[14:17], a[64:71], v87
  ds_write_b128 v83, v[164:167] offset:44032
  v_smfmac_f32_16x16x64_bf16 v[172:175], v[18:21], a[104:111], v87
  v_smfmac_f32_16x16x64_bf16 v[172:175], v[22:25], a[144:151], v87
  v_smfmac_f32_16x16x64_bf16 v[172:175], v[26:29], a[184:191], v87
  v_smfmac_f32_16x16x64_bf16 v[172:175], v[30:33], a[224:231], v87
  v_smfmac_f32_16x16x64_bf16 v[176:179], v[10:13], a[32:39], v87
  v_smfmac_f32_16x16x64_bf16 v[176:179], v[14:17], a[72:79], v87
  ds_write_b128 v83, v[168:171] offset:44544
  v_smfmac_f32_16x16x64_bf16 v[176:179], v[18:21], a[112:119], v87
  v_smfmac_f32_16x16x64_bf16 v[176:179], v[22:25], a[152:159], v87
  v_smfmac_f32_16x16x64_bf16 v[176:179], v[26:29], a[192:199], v87
  v_smfmac_f32_16x16x64_bf16 v[176:179], v[30:33], a[232:239], v87
  s_nop 1
  ds_write_b128 v83, v[172:175] offset:45056
  s_mov_b32 exec_hi, 0
  s_nop 3
  ds_write_b128 v83, v[176:179] offset:45568
  s_mov_b64 exec, -1
  s_waitcnt lgkmcnt(0)
  s_barrier
  s_cmp_ge_u32 s72, 3
  s_cbranch_scc1 L_noy_12
  ds_read_b128 v[18:21], v84 offset:43520
  ds_read_b128 v[22:25], v84 offset:46080
  ds_read_b128 v[26:29], v84 offset:48640
  ds_read_b128 v[30:33], v84 offset:51200
  s_waitcnt lgkmcnt(2)
  v_pk_add_f32 v[18:19], v[18:19], v[22:23]
  v_pk_add_f32 v[20:21], v[20:21], v[24:25]
  s_waitcnt lgkmcnt(0)
  v_pk_add_f32 v[26:27], v[26:27], v[30:31]
  v_pk_add_f32 v[28:29], v[28:29], v[32:33]
  v_pk_add_f32 v[64:65], v[18:19], v[26:27]
  v_pk_add_f32 v[66:67], v[20:21], v[28:29]
  v_add_u32 v64, 0x80, v64
  v_perm_b32 v64, v76, v64, s16
  v_add_u32 v65, 0x80, v65
  v_perm_b32 v65, v76, v65, s17
  v_add_u32 v66, 0x80, v66
  v_perm_b32 v66, v76, v66, s18
  v_add_u32 v67, 0x80, v67
  v_perm_b32 v67, v76, v67, s19
  buffer_store_dwordx4 v[64:67], v5, s[60:63], 0 offen sc1
  s_branch L_pubd_13
L_noy_12:
  ds_read2_b32 v[54:55], v51 offset0:128 offset1:160
  ds_read2_b32 v[56:57], v51 offset0:192 offset1:224
  s_waitcnt lgkmcnt(0)
  v_add_f32 v54, v54, v55
  v_add_f32 v56, v56, v57
  v_add_f32 v54, v54, v56
  v_cvt_pk_bf16_f32 v54, v54, v54
  v_and_b32 v54, 0xffff0000, v54
  v_mul_f32 v55, 0xbfb8aa3b, v54
  v_exp_f32 v55, v55
  s_nop 0
  v_add_f32 v55, 1.0, v55
  v_rcp_f32 v55, v55
  s_nop 0
  v_mul_f32 v55, v54, v55
  v_cvt_pk_bf16_f32 v55, v55, v55
  v_and_b32 v52, 0xffff0000, v55
L_pubd_13:
  s_cmp_eq_u32 s2, 232
  s_cbranch_scc1 L_epoch
  s_cmp_eq_u32 s52, 0
  s_cbranch_scc1 L_fin
  buffer_load_dwordx4 v[200:203], v42, s[60:63], 0 offen offset:0 sc1
  buffer_load_dwordx4 v[204:207], v42, s[60:63], 0 offen offset:1024 sc1
  buffer_load_dwordx4 v[208:211], v42, s[60:63], 0 offen offset:2048 sc1
  buffer_load_dwordx4 v[212:215], v42, s[60:63], 0 offen offset:3072 sc1
  s_mov_b32 s88, 1048576
  s_mov_b32 s83, 15
L_yloop_14:
  s_bitcmp0_b32 s83, 0
  s_cbranch_scc1 L_ynx_16
  v_perm_b32 v20, v201, v200, s14
  v_perm_b32 v21, v203, v202, s14
  v_lshl_or_b32 v20, v21, 16, v20
  v_cmp_ne_u32 s[28:29], v20, v76
  s_nop 1
  s_wqm_b64 exec, s[28:29]
  s_cbranch_scc1 L_ybad_17
  s_mov_b64 exec, -1
  v_and_b32 v36, 0xffffff00, v200
  v_and_b32 v37, 0xffffff00, v201
  v_and_b32 v38, 0xffffff00, v202
  v_and_b32 v39, 0xffffff00, v203
  s_bitset0_b32 s83, 0
  s_branch L_ynx_16
L_ybad_17:
  buffer_load_dwordx4 v[200:203], v42, s[60:63], 0 offen offset:0 sc1
  s_mov_b64 exec, -1
L_ynx_16:
  s_bitcmp0_b32 s83, 1
  s_cbranch_scc1 L_ynx_18
  v_perm_b32 v20, v205, v204, s14
  v_perm_b32 v21, v207, v206, s14
  v_lshl_or_b32 v20, v21, 16, v20
  v_cmp_ne_u32 s[30:31], v20, v76
  s_nop 1
  s_wqm_b64 exec, s[30:31]
  s_cbranch_scc1 L_ybad_19
  s_mov_b64 exec, -1
  v_and_b32 v24, 0xffffff00, v204
  v_and_b32 v25, 0xffffff00, v205
  v_and_b32 v26, 0xffffff00, v206
  v_and_b32 v27, 0xffffff00, v207
  s_bitset0_b32 s83, 1
  s_branch L_ynx_18
L_ybad_19:
  buffer_load_dwordx4 v[204:207], v42, s[60:63], 0 offen offset:1024 sc1
  s_mov_b64 exec, -1
L_ynx_18:
  s_bitcmp0_b32 s83, 2
  s_cbranch_scc1 L_ynx_20
  v_perm_b32 v20, v209, v208, s14
  v_perm_b32 v21, v211, v210, s14
  v_lshl_or_b32 v20, v21, 16, v20
  v_cmp_ne_u32 s[32:33], v20, v76
  s_nop 1
  s_wqm_b64 exec, s[32:33]
  s_cbranch_scc1 L_ybad_21
  s_mov_b64 exec, -1
  v_and_b32 v28, 0xffffff00, v208
  v_and_b32 v29, 0xffffff00, v209
  v_and_b32 v30, 0xffffff00, v210
  v_and_b32 v31, 0xffffff00, v211
  s_bitset0_b32 s83, 2
  s_branch L_ynx_20
L_ybad_21:
  buffer_load_dwordx4 v[208:211], v42, s[60:63], 0 offen offset:2048 sc1
  s_mov_b64 exec, -1
L_ynx_20:
  s_bitcmp0_b32 s83, 3
  s_cbranch_scc1 L_ynx_22
  v_perm_b32 v20, v213, v212, s14
  v_perm_b32 v21, v215, v214, s14
  v_lshl_or_b32 v20, v21, 16, v20
  v_cmp_ne_u32 s[34:35], v20, v76
  s_nop 1
  s_wqm_b64 exec, s[34:35]
  s_cbranch_scc1 L_ybad_23
  s_mov_b64 exec, -1
  v_and_b32 v32, 0xffffff00, v212
  v_and_b32 v33, 0xffffff00, v213
  v_and_b32 v34, 0xffffff00, v214
  v_and_b32 v35, 0xffffff00, v215
  s_bitset0_b32 s83, 3
  s_branch L_ynx_22
L_ybad_23:
  buffer_load_dwordx4 v[212:215], v42, s[60:63], 0 offen offset:3072 sc1
  s_mov_b64 exec, -1
L_ynx_22:
  s_cmp_eq_u32 s83, 0
  s_cbranch_scc1 L_yok_15
  s_waitcnt vmcnt(6)
  s_sub_u32 s88, s88, 1
  s_cbranch_scc0 L_yloop_14
L_yok_15:
  v_pk_add_f32 v[36:37], v[36:37], v[24:25]
  v_pk_add_f32 v[38:39], v[38:39], v[26:27]
  v_pk_add_f32 v[28:29], v[28:29], v[32:33]
  v_pk_add_f32 v[30:31], v[30:31], v[34:35]
  v_pk_add_f32 v[36:37], v[36:37], v[28:29]
  v_pk_add_f32 v[38:39], v[38:39], v[30:31]
  s_nop 0
  s_nop 0
  v_permlane32_swap_b32 v36, v37
  v_permlane32_swap_b32 v38, v39
  s_nop 0
  v_add_f32 v36, v36, v37
  v_add_f32 v38, v38, v39
  s_nop 1
  v_permlane16_swap_b32 v36, v38
  s_nop 0
  v_add_f32 v36, v36, v38
  s_nop 1
  v_add_f32_dpp v36, v36, v36 row_ror:8 row_mask:0xf bank_mask:0xf
  ds_write_b32 v50, v36 offset:53760
  s_waitcnt lgkmcnt(0)
  s_barrier
  s_cmp_lg_u32 s72, 3
  s_cbranch_scc1 L_fin
  ds_read2_b32 v[54:55], v51 offset0:0 offset1:32
  ds_read2_b32 v[56:57], v51 offset0:64 offset1:96
  s_mov_b32 exec_hi, 0
  s_waitcnt lgkmcnt(0)
  v_add_f32 v54, v54, v55
  v_add_f32 v56, v56, v57
  v_add_f32 v54, v54, v56
  v_cvt_pk_bf16_f32 v54, v54, v54
  v_and_b32 v54, 0xffff0000, v54
  v_mul_f32 v54, v54, v52
  v_cvt_pk_bf16_f32 v54, v54, v54
  v_and_b32 v54, 0xffff0000, v54
  v_add_f32 v54, v54, v48
  v_cvt_pk_bf16_f32 v54, v54, v54
  buffer_store_short v54, v49, s[64:67], 0 offen
  s_mov_b64 exec, -1
  s_branch L_fin
L_epoch:
  s_cmp_lg_u32 s72, 0
  s_cbranch_scc1 L_fin
  v_lshlrev_b32 v13, 7, v1
  v_add_u32 v13, 1220608, v13
  s_mov_b32 s81, 0
  buffer_load_dwordx4 v[16:19], v13, s[60:63], s81 offen sc1
  s_mov_b32 s81, 8192
  buffer_load_dwordx4 v[20:23], v13, s[60:63], s81 offen sc1
  s_mov_b32 s81, 16384
  buffer_load_dwordx4 v[24:27], v13, s[60:63], s81 offen sc1
  s_mov_b32 s81, 24576
  buffer_load_dwordx4 v[28:31], v13, s[60:63], s81 offen sc1
  s_waitcnt vmcnt(0)
  s_mov_b32 s88, 65536
L_eploop_25:
  v_perm_b32 v56, v17, v16, s14
  v_perm_b32 v57, v19, v18, s14
  v_lshl_or_b32 v56, v57, 16, v56
  v_cmp_ne_u32 vcc, v56, v76
  v_perm_b32 v56, v21, v20, s14
  v_perm_b32 v57, v23, v22, s14
  v_lshl_or_b32 v56, v57, 16, v56
  v_cmp_ne_u32 s[84:85], v56, v76
  s_nop 3
  s_or_b64 vcc, vcc, s[84:85]
  v_perm_b32 v56, v25, v24, s14
  v_perm_b32 v57, v27, v26, s14
  v_lshl_or_b32 v56, v57, 16, v56
  v_cmp_ne_u32 s[84:85], v56, v76
  s_nop 3
  s_or_b64 vcc, vcc, s[84:85]
  v_perm_b32 v56, v29, v28, s14
  v_perm_b32 v57, v31, v30, s14
  v_lshl_or_b32 v56, v57, 16, v56
  v_cmp_ne_u32 s[84:85], v56, v76
  s_nop 3
  s_or_b64 vcc, vcc, s[84:85]
  s_nop 4
  s_cbranch_vccz L_epok_24
  s_sub_u32 s88, s88, 1
  s_cbranch_scc1 L_epok_24
  s_sleep 8
  s_mov_b32 s81, 0
  buffer_load_dwordx4 v[16:19], v13, s[60:63], s81 offen sc1
  s_mov_b32 s81, 8192
  buffer_load_dwordx4 v[20:23], v13, s[60:63], s81 offen sc1
  s_mov_b32 s81, 16384
  buffer_load_dwordx4 v[24:27], v13, s[60:63], s81 offen sc1
  s_mov_b32 s81, 24576
  buffer_load_dwordx4 v[28:31], v13, s[60:63], s81 offen sc1
  s_waitcnt vmcnt(0)
  s_branch L_eploop_25
L_epok_24:
  v_mov_b32 v16, s68
  s_mov_b32 s81, 1253376
  s_mov_b64 exec, 1
  buffer_store_dword v16, off, s[60:63], s81
  s_mov_b64 exec, -1
L_fin:
L_end:
  s_endpgm
.section .rodata,"a"
.p2align 6
.amdhsa_kernel recurrent_scan__gqa_block_cached__geglu_ffn__decode_kernel
  .amdhsa_next_free_vgpr 512
  .amdhsa_next_free_sgpr 102
  .amdhsa_accum_offset 256
  .amdhsa_group_segment_fixed_size 0
  .amdhsa_kernarg_size 96
  .amdhsa_user_sgpr_count 2
  .amdhsa_user_sgpr_kernarg_segment_ptr 1
  .amdhsa_system_sgpr_workgroup_id_x 1
.end_amdhsa_kernel
```
